```python
import torch

def _softmax(x, axis=-1):
    return torch.softmax(x, dim=axis)

def _gelu(x):
    return torch.nn.functional.gelu(x, approximate='tanh')

def _silu(x):
    return torch.nn.functional.silu(x)

def _sigmoid(x):
    return torch.sigmoid(x)

def _layernorm(x, axis=-1, eps=1e-05):
    m = x.mean(dim=axis, keepdim=True)
    v = x.var(dim=axis, keepdim=True, unbiased=False)
    return (x - m) / torch.sqrt(v + eps)

def _scatter_add(tgt, idx, src, axis=0):
    return tgt.clone().index_add_(axis, idx, src)

def _segment_sum(src, seg, n):
    out = torch.zeros((n,) + src.shape[1:], dtype=src.dtype)
    return out.index_add_(0, seg, src)

def _pad(x, pw):
    flat = tuple((v for pair in reversed(pw) for v in pair))
    return torch.nn.functional.pad(x, flat)
kernel_name = 'adaLN_cond__sliding_block_cached__mixer_channel_mlp__decode'

def setup_inputs():

    _w = lambda a: (lambda t: t.to(torch.bfloat16) if t.is_floating_point() else t)(torch.as_tensor(a))

    def _A_setup():
        B, Sq, D = (2, 1, 1024)
        Hq, Hkv, Sk, Dh = (32, 4, 32768, 128)
        assert Hq % Hkv == 0, (Hq, Hkv)
        return {'x': _w((lambda *s: torch.randn(*s, dtype=torch.bfloat16) * 0.05)(B, Sq, D)), 'k_cache': _w((lambda *s: torch.randn(*s, dtype=torch.bfloat16) * 3.2)(B, Hkv, Sk, Dh)), 'v_cache': _w((lambda *s: torch.randn(*s, dtype=torch.bfloat16) * 0.4)(B, Hkv, Sk, Dh)), 'wq': _w((lambda *s: torch.randn(*s, dtype=torch.bfloat16) * 3.2)(D, Hq * Dh) * D ** (-0.5)), 'wo': _w((lambda *s: torch.randn(*s, dtype=torch.bfloat16) * 0.4)(Hq * Dh, D) * (Hq * Dh) ** (-0.5))}
    _A_in = _A_setup()

    def _B_setup():
        B, S, D, F = (2, 1, 1024, 3584)
        return {'x': _w((lambda *s: torch.randn(*s, dtype=torch.bfloat16) * 0.05)(B, S, D)), 'w1': _w((lambda *s: torch.randn(*s, dtype=torch.bfloat16) * 3.2)(D, F) * D ** (-0.5)), 'b1': _w((lambda *s: torch.randn(*s, dtype=torch.bfloat16) * 3.2)(F)), 'w2': _w((lambda *s: torch.randn(*s, dtype=torch.bfloat16) * 0.2)(F, D) * F ** (-0.5)), 'b2': _w((lambda *s: torch.randn(*s, dtype=torch.bfloat16) * 0.4)(D))}
    _B_in = _B_setup()
    return {'A_x': _A_in['x'], 'A_k_cache': _A_in['k_cache'], 'A_v_cache': _A_in['v_cache'], 'A_wq': _A_in['wq'], 'A_wo': _A_in['wo'], 'B_x': _B_in['x'], 'B_w1': _B_in['w1'], 'B_b1': _B_in['b1'], 'B_w2': _B_in['w2'], 'B_b2': _B_in['b2'], 'c': _w((lambda *s: torch.randn(*s, dtype=torch.bfloat16) * 0.2)(2, 1024) * 8.0), 'w_mod': _w((lambda *s: torch.randn(*s, dtype=torch.bfloat16) * 0.2)(1024, 6 * 1024) * 1024 ** (-0.5) * 8.0)}

def reference(A_x, A_k_cache, A_v_cache, A_wq, A_wo, B_x, B_w1, B_b1, B_w2, B_b2, c, w_mod):

    def _A_ref(x, k_cache, v_cache, wq, wo):
        B, Sq, D = x.shape
        Hq, Dh = (32, 128)
        Hkv, Sk = (k_cache.shape[1], k_cache.shape[2])
        W = min(4096, max(256, Sk // 4))
        rep = Hq // Hkv
        q = (lambda x, *d: x.permute(*d))((x @ wq).reshape(B, Sq, Hq, Dh), 0, 2, 1, 3)
        k = (lambda x, n, axis: torch.repeat_interleave(x, n, dim=axis))(k_cache[:, :, Sk - W:, :], rep, axis=1)
        v = (lambda x, n, axis: torch.repeat_interleave(x, n, dim=axis))(v_cache[:, :, Sk - W:, :], rep, axis=1)
        scores = torch.einsum('bhqd,bhkd->bhqk', q, k) * Dh ** (-0.5)
        p = _softmax(scores, axis=-1)
        o = torch.einsum('bhqk,bhkd->bhqd', p, v)
        return (lambda x, *d: x.permute(*d))(o, 0, 2, 1, 3).reshape(B, Sq, Hq * Dh) @ wo

    def _B_ref(x, w1, b1, w2, b2):
        y = _layernorm(x, axis=-1)
        h = _gelu(torch.einsum('bsd,df->bsf', y, w1) + b1)
        return torch.einsum('bsf,fd->bsd', h, w2) + b2
    x = A_x
    mod = (_silu(c) @ w_mod).reshape(c.shape[0], 6, 1, -1)
    sa, ca, ga, sb, cb, gb = (mod[:, 0].clone(), mod[:, 1].clone(), mod[:, 2].clone(), mod[:, 3].clone(), mod[:, 4].clone(), mod[:, 5].clone())
    h = _layernorm(x, axis=-1) * (1 + ca) + sa
    x = x + ga * _A_ref(h, A_k_cache, A_v_cache, A_wq, A_wo)
    h = _layernorm(x, axis=-1) * (1 + cb) + sb
    x = x + gb * _B_ref(h, B_w1, B_b1, B_w2, B_b2)
    return x
```

```asm
; @launch grid=(256,1,1) block=(576,1,1) lds=163840
.amdgcn_target "amdgcn-amd-amdhsa--gfx950"
.text
.globl adaLN_cond__sliding_block_cached__mixer_channel_mlp__decode_kernel
.p2align 8
.type adaLN_cond__sliding_block_cached__mixer_channel_mlp__decode_kernel,@function
adaLN_cond__sliding_block_cached__mixer_channel_mlp__decode_kernel:
  s_load_dwordx16 s[16:31], s[0:1], 0
  s_load_dwordx8 s[32:39], s[0:1], 64
  s_load_dwordx4 s[40:43], s[0:1], 96
  s_load_dwordx2 s[44:45], s[0:1], 112
  s_cmp_ge_u32 s2, 256
  s_cbranch_scc1 L_exit
  v_and_b32 v1, 63, v0
  v_lshrrev_b32 v4, 6, v0
  s_nop 0
  v_readfirstlane_b32 s4, v4
  s_getpc_b64 s[14:15]
L_pc0:
  s_bfe_u32 s10, s2, 0x10003
  s_mul_i32 s10, s10, 9
  s_add_u32 s10, s10, s4
  s_lshl_b32 s10, s10, 10
  s_add_u32 s14, s14, s10
  s_addc_u32 s15, s15, 0
  v_lshlrev_b32 v5, 4, v1
  s_cmp_le_u32 s10, L_codeend-L_pc0-1024
  s_cbranch_scc0 L_nopf
  global_load_dwordx4 v[88:91], v5, s[14:15]
L_nopf:
  v_and_b32 v2, 15, v1
  v_lshrrev_b32 v3, 4, v1
  v_mov_b32 v12, 0
  s_lshr_b32 s6, s2, 5
  s_and_b32 s7, s2, 31
  s_and_b32 s81, s2, 7
  s_lshr_b32 s82, s2, 3
  s_lshl_b32 s83, s81, 5
  s_add_u32 s83, s83, s82
  s_cmp_eq_u32 s4, 8
  s_cbranch_scc0 L_compute
L_pump:
  v_lshlrev_b32 v4, 2, v1
  s_mov_b32 exec_lo, 0xffffffff
  s_mov_b32 exec_hi, 0x00000000
  ds_write_b32 v4, v12 offset:8192
  s_mov_b64 exec, -1
  v_and_b32 v4, 1, v3
  v_lshlrev_b32 v4, 1, v4
  v_and_b32 v5, 7, v1
  v_xor_b32 v4, v4, v5
  v_lshlrev_b32 v14, 4, v4
  v_lshrrev_b32 v15, 3, v1
  s_mov_b32 s8, 12288
  v_mad_u32_u24 v17, v15, s8, v14
  v_xor_b32 v18, 64, v17
  s_lshl_b32 s79, s6, 7
  s_mul_i32 s10, s79, 12288
  s_lshl_b32 s11, s81, 1
  s_and_b32 s13, s82, 1
  s_add_u32 s11, s11, s13
  s_bfe_u32 s13, s82, 0x10001
  s_lshl_b32 s13, s13, 4
  s_add_u32 s11, s11, s13
  s_lshl_b32 s11, s11, 7
  s_add_u32 s11, s10, s11
  s_waitcnt lgkmcnt(0)
  s_barrier
  s_add_u32 s52, s38, s11
  s_addc_u32 s53, s39, 0
  s_load_dword s5, s[44:45], 0
  s_add_u32 s46, s44, 1048576
  s_addc_u32 s47, s45, 0
  s_mul_i32 s10, s2, 12416
  s_add_u32 s48, s46, s10
  s_addc_u32 s49, s47, 0
  v_mov_b32 v36, -1
  v_mov_b32 v37, -1
  v_mov_b32 v38, -1
  v_mov_b32 v39, -1
  v_lshlrev_b32 v40, 4, v1
  s_add_u32 s50, s48, 0
  s_addc_u32 s51, s49, 0
  global_store_dwordx4 v40, v[36:39], s[50:51] offset:0 sc1
  global_store_dwordx4 v40, v[36:39], s[50:51] offset:1024 sc1
  v_mov_b32 v35, 1
  s_mov_b32 m0, 12288
  s_nop 0
  global_load_lds_dwordx4 v17, s[52:53] nt
  s_add_u32 m0, m0, 1024
  s_add_u32 s52, s52, 98304
  s_addc_u32 s53, s53, 0
  global_load_lds_dwordx4 v18, s[52:53] nt
  s_add_u32 m0, m0, 1024
  s_add_u32 s52, s52, 98304
  s_addc_u32 s53, s53, 0
  global_load_lds_dwordx4 v17, s[52:53] nt
  s_add_u32 m0, m0, 1024
  s_add_u32 s52, s52, 98304
  s_addc_u32 s53, s53, 0
  global_load_lds_dwordx4 v18, s[52:53] nt
  s_add_u32 m0, m0, 1024
  s_add_u32 s52, s52, 98304
  s_addc_u32 s53, s53, 0
  global_load_lds_dwordx4 v17, s[52:53] nt
  s_add_u32 m0, m0, 1024
  s_add_u32 s52, s52, 98304
  s_addc_u32 s53, s53, 0
  global_load_lds_dwordx4 v18, s[52:53] nt
  s_add_u32 m0, m0, 1024
  s_add_u32 s52, s52, 98304
  s_addc_u32 s53, s53, 0
  global_load_lds_dwordx4 v17, s[52:53] nt
  s_add_u32 m0, m0, 1024
  s_add_u32 s52, s52, 98304
  s_addc_u32 s53, s53, 0
  global_load_lds_dwordx4 v18, s[52:53] nt
  s_add_u32 m0, m0, 1024
  s_add_u32 s52, s52, 98304
  s_addc_u32 s53, s53, 0
  global_load_lds_dwordx4 v17, s[52:53] nt
  s_add_u32 m0, m0, 1024
  s_add_u32 s52, s52, 98304
  s_addc_u32 s53, s53, 0
  global_load_lds_dwordx4 v18, s[52:53] nt
  s_add_u32 m0, m0, 1024
  s_add_u32 s52, s52, 98304
  s_addc_u32 s53, s53, 0
  global_load_lds_dwordx4 v17, s[52:53] nt
  s_add_u32 m0, m0, 1024
  s_add_u32 s52, s52, 98304
  s_addc_u32 s53, s53, 0
  global_load_lds_dwordx4 v18, s[52:53] nt
  s_add_u32 m0, m0, 1024
  s_add_u32 s52, s52, 98304
  s_addc_u32 s53, s53, 0
  global_load_lds_dwordx4 v17, s[52:53] nt
  s_add_u32 m0, m0, 1024
  s_add_u32 s52, s52, 98304
  s_addc_u32 s53, s53, 0
  global_load_lds_dwordx4 v18, s[52:53] nt
  s_add_u32 m0, m0, 1024
  s_add_u32 s52, s52, 98304
  s_addc_u32 s53, s53, 0
  global_load_lds_dwordx4 v17, s[52:53] nt
  s_add_u32 m0, m0, 1024
  s_add_u32 s52, s52, 98304
  s_addc_u32 s53, s53, 0
  global_load_lds_dwordx4 v18, s[52:53] nt
  s_add_u32 m0, m0, 1024
  s_add_u32 s52, s52, 98304
  s_addc_u32 s53, s53, 0
  global_store_dwordx4 v40, v[36:39], s[50:51] offset:2048 sc1
  global_store_dwordx4 v40, v[36:39], s[50:51] offset:3072 sc1
  s_add_u32 s50, s50, 4096
  s_addc_u32 s51, s51, 0
  global_store_dwordx4 v40, v[36:39], s[50:51] offset:0 sc1
  global_store_dwordx4 v40, v[36:39], s[50:51] offset:1024 sc1
  global_store_dwordx4 v40, v[36:39], s[50:51] offset:2048 sc1
  global_store_dwordx4 v40, v[36:39], s[50:51] offset:3072 sc1
  s_add_u32 s50, s50, 4096
  s_addc_u32 s51, s51, 0
  global_store_dwordx4 v40, v[36:39], s[50:51] offset:0 sc1
  global_store_dwordx4 v40, v[36:39], s[50:51] offset:1024 sc1
  global_store_dwordx4 v40, v[36:39], s[50:51] offset:2048 sc1
  global_store_dwordx4 v40, v[36:39], s[50:51] offset:3072 sc1
  v_lshlrev_b32 v4, 1, v3
  v_xor_b32 v4, v4, v2
  v_lshlrev_b32 v16, 4, v4
  s_mov_b32 s8, 8192
  v_mad_u32_u24 v21, v3, s8, v16
  v_xor_b32 v22, 128, v21
  s_lshl_b32 s10, s81, 20
  s_lshl_b32 s11, s82, 8
  s_add_u32 s10, s10, s11
  s_add_u32 s52, s22, s10
  s_addc_u32 s53, s23, 0
  s_mov_b32 m0, 28672
  s_nop 0
  global_load_lds_dwordx4 v21, s[52:53] nt
  s_add_u32 m0, m0, 1024
  s_add_u32 s52, s52, 32768
  s_addc_u32 s53, s53, 0
  global_load_lds_dwordx4 v21, s[52:53] nt
  s_add_u32 m0, m0, 1024
  s_add_u32 s52, s52, 32768
  s_addc_u32 s53, s53, 0
  global_load_lds_dwordx4 v22, s[52:53] nt
  s_add_u32 m0, m0, 1024
  s_add_u32 s52, s52, 32768
  s_addc_u32 s53, s53, 0
  global_load_lds_dwordx4 v22, s[52:53] nt
  s_add_u32 m0, m0, 1024
  s_add_u32 s52, s52, 32768
  s_addc_u32 s53, s53, 0
  global_load_lds_dwordx4 v21, s[52:53] nt
  s_add_u32 m0, m0, 1024
  s_add_u32 s52, s52, 32768
  s_addc_u32 s53, s53, 0
  global_load_lds_dwordx4 v21, s[52:53] nt
  s_add_u32 m0, m0, 1024
  s_add_u32 s52, s52, 32768
  s_addc_u32 s53, s53, 0
  global_load_lds_dwordx4 v22, s[52:53] nt
  s_add_u32 m0, m0, 1024
  s_add_u32 s52, s52, 32768
  s_addc_u32 s53, s53, 0
  global_load_lds_dwordx4 v22, s[52:53] nt
  s_add_u32 m0, m0, 1024
  s_add_u32 s52, s52, 32768
  s_addc_u32 s53, s53, 0
  v_xor_b32 v4, v3, v2
  v_lshlrev_b32 v4, 4, v4
  v_lshl_add_u32 v27, v3, 8, v4
  v_xor_b32 v28, 64, v27
  v_xor_b32 v29, 128, v27
  v_xor_b32 v30, 192, v27
  v_lshl_add_u32 v25, v3, 8, v16
  v_xor_b32 v26, 128, v25
  s_mov_b32 s8, 12288
  v_mad_u32_u24 v23, v3, s8, v16
  v_xor_b32 v24, 128, v23
  v_lshrrev_b32 v4, 5, v1
  v_lshlrev_b32 v5, 1, v4
  v_and_b32 v6, 31, v1
  v_xor_b32 v5, v5, v6
  v_lshlrev_b32 v5, 4, v5
  v_lshl_add_u32 v31, v4, 11, v5
  v_xor_b32 v32, 64, v31
  v_xor_b32 v33, 128, v31
  v_xor_b32 v34, 192, v31
  s_mov_b32 s8, 7168
  v_mad_u32_u24 v19, v15, s8, v14
  v_xor_b32 v20, 64, v19
  s_waitcnt vmcnt(34)
  s_waitcnt lgkmcnt(0)
  s_mul_i32 s5, s5, 1664525
  s_add_u32 s5, s5, 1013904223
  s_lshl_b32 s10, s2, 7
  s_add_u32 s10, s10, 131072
  v_mov_b32 v4, s10
  v_mov_b32 v6, s5
  v_mov_b32 v7, s96
  s_mov_b64 exec, 1
  global_store_dwordx2 v4, v[6:7], s[44:45] sc1
  s_mov_b64 exec, -1
  s_waitcnt vmcnt(19)
  v_mov_b32 v35, 18
  s_mov_b64 exec, 1
  ds_write_b32 v12, v35 offset:8192
  s_mov_b64 exec, -1
  s_waitcnt vmcnt(9)
  v_mov_b32 v35, 28
  s_mov_b64 exec, 1
  ds_write_b32 v12, v35 offset:8192
  s_mov_b64 exec, -1
  s_mov_b32 s84, 36
  v_mov_b32 v48, v21
  v_mov_b32 v49, v21
  v_mov_b32 v50, v22
  v_mov_b32 v51, v22
  v_mov_b32 v52, v21
  v_mov_b32 v53, v21
  v_mov_b32 v54, v22
  v_mov_b32 v55, v22
  s_mov_b32 s87, 32768
  s_mov_b32 s92, 24
  s_getpc_b64 s[88:89]
L_call_26:
  s_add_u32 s88, s88, L_stream-L_call_26
  s_addc_u32 s89, s89, 0
  s_swappc_b64 s[90:91], s[88:89]
  s_lshl_b32 s10, s81, 15
  s_lshl_b32 s11, s82, 7
  s_add_u32 s10, s10, s11
  s_add_u32 s10, s10, 28672
  s_lshl_b32 s13, s10, 8
  s_add_u32 s52, s18, s13
  s_addc_u32 s53, s19, 0
  s_mov_b32 m0, 61440
  v_mov_b32 v48, v27
  v_mov_b32 v49, v28
  v_mov_b32 v50, v29
  v_mov_b32 v51, v30
  v_mov_b32 v52, v27
  v_mov_b32 v53, v28
  v_mov_b32 v54, v29
  v_mov_b32 v55, v30
  s_mov_b32 s87, 1024
  s_mov_b32 s92, 32
  s_getpc_b64 s[88:89]
L_call_27:
  s_add_u32 s88, s88, L_stream-L_call_27
  s_addc_u32 s89, s89, 0
  s_swappc_b64 s[90:91], s[88:89]
  s_add_u32 s52, s20, s13
  s_addc_u32 s53, s21, 0
  s_mov_b32 m0, 94208
  v_mov_b32 v48, v25
  v_mov_b32 v49, v25
  v_mov_b32 v50, v26
  v_mov_b32 v51, v26
  v_mov_b32 v52, v25
  v_mov_b32 v53, v25
  v_mov_b32 v54, v26
  v_mov_b32 v55, v26
  s_mov_b32 s87, 1024
  s_mov_b32 s92, 32
  s_getpc_b64 s[88:89]
L_call_28:
  s_add_u32 s88, s88, L_stream-L_call_28
  s_addc_u32 s89, s89, 0
  s_swappc_b64 s[90:91], s[88:89]
  s_lshr_b32 s10, s83, 2
  s_lshl_b32 s10, s10, 17
  s_and_b32 s11, s82, 3
  s_lshl_b32 s11, s11, 9
  s_add_u32 s10, s10, s11
  s_add_u32 s52, s24, s10
  s_addc_u32 s53, s25, 0
  s_mov_b32 m0, 126976
  v_mov_b32 v48, v31
  v_mov_b32 v49, v32
  v_mov_b32 v50, v31
  v_mov_b32 v51, v32
  v_mov_b32 v52, v33
  v_mov_b32 v53, v34
  v_mov_b32 v54, v33
  v_mov_b32 v55, v34
  s_mov_b32 s87, 4096
  s_mov_b32 s92, 32
  s_getpc_b64 s[88:89]
L_call_29:
  s_add_u32 s88, s88, L_stream-L_call_29
  s_addc_u32 s89, s89, 0
  s_swappc_b64 s[90:91], s[88:89]
  ds_read_b32 v4, v12 offset:8256
  s_waitcnt lgkmcnt(0)
  v_readfirstlane_b32 s15, v4
  s_nop 0
  s_cmp_ge_u32 s15, 8
  s_cbranch_scc1 L_fr_30_o
L_dr_31:
  s_getreg_b32 s85, hwreg(HW_REG_IB_STS, 0, 4)
  s_getreg_b32 s86, hwreg(HW_REG_IB_STS, 22, 2)
  s_lshl_b32 s86, s86, 4
  s_or_b32 s85, s85, s86
  s_cmp_le_u32 s85, 14
  s_cbranch_scc0 L_ph_33
  s_cmp_le_u32 s85, 6
  s_cbranch_scc0 L_ph_34
  s_cmp_le_u32 s85, 2
  s_cbranch_scc0 L_ph_35
  s_waitcnt vmcnt(2)
  s_movk_i32 s14, 2
  s_branch L_pp_32
L_ph_35:
  s_waitcnt vmcnt(6)
  s_movk_i32 s14, 6
  s_branch L_pp_32
L_ph_34:
  s_cmp_le_u32 s85, 10
  s_cbranch_scc0 L_ph_36
  s_waitcnt vmcnt(10)
  s_movk_i32 s14, 10
  s_branch L_pp_32
L_ph_36:
  s_waitcnt vmcnt(14)
  s_movk_i32 s14, 14
  s_branch L_pp_32
L_ph_33:
  s_cmp_le_u32 s85, 24
  s_cbranch_scc0 L_ph_37
  s_cmp_le_u32 s85, 18
  s_cbranch_scc0 L_ph_38
  s_waitcnt vmcnt(18)
  s_movk_i32 s14, 18
  s_branch L_pp_32
L_ph_38:
  s_waitcnt vmcnt(24)
  s_movk_i32 s14, 24
  s_branch L_pp_32
L_ph_37:
  s_cmp_le_u32 s85, 32
  s_cbranch_scc0 L_ph_39
  s_waitcnt vmcnt(32)
  s_movk_i32 s14, 32
  s_branch L_pp_32
L_ph_39:
  s_waitcnt vmcnt(63)
  s_movk_i32 s14, 63
  s_branch L_pp_32
L_pp_32:
  s_sub_u32 s14, s84, s14
  s_max_i32 s14, s14, 0
  v_mov_b32 v35, s14
  s_mov_b64 exec, 1
  ds_write_b32 v12, v35 offset:8192
  s_mov_b64 exec, -1
  s_cmp_gt_u32 s85, 2
  s_cbranch_scc1 L_dr_31
  s_waitcnt vmcnt(0)
  v_mov_b32 v35, s84
  s_mov_b64 exec, 1
  ds_write_b32 v12, v35 offset:8192
  s_mov_b64 exec, -1
  s_mov_b32 s78, 0
L_fr_30_s:
  s_sleep 1
  ds_read_b32 v4, v12 offset:8256
  s_waitcnt lgkmcnt(0)
  v_readfirstlane_b32 s15, v4
  s_add_u32 s78, s78, 1
  s_cmp_gt_u32 s78, 1048576
  s_cbranch_scc1 L_fr_30_o
  s_cmp_ge_u32 s15, 8
  s_cbranch_scc0 L_fr_30_s
L_fr_30_o:
  s_mul_i32 s10, s79, 12288
  s_lshl_b32 s11, s7, 8
  s_add_u32 s10, s10, s11
  s_add_u32 s10, s10, 4096
  s_add_u32 s52, s38, s10
  s_addc_u32 s53, s39, 0
  s_mov_b32 m0, 28672
  v_mov_b32 v48, v23
  v_mov_b32 v49, v23
  v_mov_b32 v50, v24
  v_mov_b32 v51, v24
  v_mov_b32 v52, v23
  v_mov_b32 v53, v23
  v_mov_b32 v54, v24
  v_mov_b32 v55, v24
  s_mov_b32 s87, 49152
  s_mov_b32 s92, 32
  s_getpc_b64 s[88:89]
L_call_40:
  s_add_u32 s88, s88, L_stream-L_call_40
  s_addc_u32 s89, s89, 0
  s_swappc_b64 s[90:91], s[88:89]
  s_cmp_lt_u32 s2, 224
  s_cbranch_scc1 L_pump_F
L_dr_41:
  s_getreg_b32 s85, hwreg(HW_REG_IB_STS, 0, 4)
  s_getreg_b32 s86, hwreg(HW_REG_IB_STS, 22, 2)
  s_lshl_b32 s86, s86, 4
  s_or_b32 s85, s85, s86
  s_cmp_le_u32 s85, 14
  s_cbranch_scc0 L_ph_43
  s_cmp_le_u32 s85, 6
  s_cbranch_scc0 L_ph_44
  s_cmp_le_u32 s85, 2
  s_cbranch_scc0 L_ph_45
  s_waitcnt vmcnt(2)
  s_movk_i32 s14, 2
  s_branch L_pp_42
L_ph_45:
  s_waitcnt vmcnt(6)
  s_movk_i32 s14, 6
  s_branch L_pp_42
L_ph_44:
  s_cmp_le_u32 s85, 10
  s_cbranch_scc0 L_ph_46
  s_waitcnt vmcnt(10)
  s_movk_i32 s14, 10
  s_branch L_pp_42
L_ph_46:
  s_waitcnt vmcnt(14)
  s_movk_i32 s14, 14
  s_branch L_pp_42
L_ph_43:
  s_cmp_le_u32 s85, 24
  s_cbranch_scc0 L_ph_47
  s_cmp_le_u32 s85, 18
  s_cbranch_scc0 L_ph_48
  s_waitcnt vmcnt(18)
  s_movk_i32 s14, 18
  s_branch L_pp_42
L_ph_48:
  s_waitcnt vmcnt(24)
  s_movk_i32 s14, 24
  s_branch L_pp_42
L_ph_47:
  s_cmp_le_u32 s85, 32
  s_cbranch_scc0 L_ph_49
  s_waitcnt vmcnt(32)
  s_movk_i32 s14, 32
  s_branch L_pp_42
L_ph_49:
  s_waitcnt vmcnt(63)
  s_movk_i32 s14, 63
  s_branch L_pp_42
L_pp_42:
  s_sub_u32 s14, s84, s14
  s_max_i32 s14, s14, 0
  v_mov_b32 v35, s14
  s_mov_b64 exec, 1
  ds_write_b32 v12, v35 offset:8192
  s_mov_b64 exec, -1
  s_cmp_gt_u32 s85, 2
  s_cbranch_scc1 L_dr_41
  s_waitcnt vmcnt(0)
  v_mov_b32 v35, s84
  s_mov_b64 exec, 1
  ds_write_b32 v12, v35 offset:8192
  s_mov_b64 exec, -1
  s_branch L_end
L_pump_F:
  s_and_b32 s74, s82, 3
  s_lshr_b32 s75, s82, 2
  s_lshl_b32 s75, s75, 3
  s_add_u32 s75, s75, s81
  ds_read_b32 v4, v12 offset:8260
  s_waitcnt lgkmcnt(0)
  v_readfirstlane_b32 s15, v4
  s_nop 0
  s_cmp_ge_u32 s15, 8
  s_cbranch_scc1 L_fr_50_o
L_dr_51:
  s_getreg_b32 s85, hwreg(HW_REG_IB_STS, 0, 4)
  s_getreg_b32 s86, hwreg(HW_REG_IB_STS, 22, 2)
  s_lshl_b32 s86, s86, 4
  s_or_b32 s85, s85, s86
  s_cmp_le_u32 s85, 14
  s_cbranch_scc0 L_ph_53
  s_cmp_le_u32 s85, 6
  s_cbranch_scc0 L_ph_54
  s_cmp_le_u32 s85, 2
  s_cbranch_scc0 L_ph_55
  s_waitcnt vmcnt(2)
  s_movk_i32 s14, 2
  s_branch L_pp_52
L_ph_55:
  s_waitcnt vmcnt(6)
  s_movk_i32 s14, 6
  s_branch L_pp_52
L_ph_54:
  s_cmp_le_u32 s85, 10
  s_cbranch_scc0 L_ph_56
  s_waitcnt vmcnt(10)
  s_movk_i32 s14, 10
  s_branch L_pp_52
L_ph_56:
  s_waitcnt vmcnt(14)
  s_movk_i32 s14, 14
  s_branch L_pp_52
L_ph_53:
  s_cmp_le_u32 s85, 24
  s_cbranch_scc0 L_ph_57
  s_cmp_le_u32 s85, 18
  s_cbranch_scc0 L_ph_58
  s_waitcnt vmcnt(18)
  s_movk_i32 s14, 18
  s_branch L_pp_52
L_ph_58:
  s_waitcnt vmcnt(24)
  s_movk_i32 s14, 24
  s_branch L_pp_52
L_ph_57:
  s_cmp_le_u32 s85, 32
  s_cbranch_scc0 L_ph_59
  s_waitcnt vmcnt(32)
  s_movk_i32 s14, 32
  s_branch L_pp_52
L_ph_59:
  s_waitcnt vmcnt(63)
  s_movk_i32 s14, 63
  s_branch L_pp_52
L_pp_52:
  s_sub_u32 s14, s84, s14
  s_max_i32 s14, s14, 0
  v_mov_b32 v35, s14
  s_mov_b64 exec, 1
  ds_write_b32 v12, v35 offset:8192
  s_mov_b64 exec, -1
  s_cmp_gt_u32 s85, 2
  s_cbranch_scc1 L_dr_51
  s_waitcnt vmcnt(0)
  v_mov_b32 v35, s84
  s_mov_b64 exec, 1
  ds_write_b32 v12, v35 offset:8192
  s_mov_b64 exec, -1
  s_mov_b32 s78, 0
L_fr_50_s:
  s_sleep 1
  ds_read_b32 v4, v12 offset:8260
  s_waitcnt lgkmcnt(0)
  v_readfirstlane_b32 s15, v4
  s_add_u32 s78, s78, 1
  s_cmp_gt_u32 s78, 1048576
  s_cbranch_scc1 L_fr_50_o
  s_cmp_ge_u32 s15, 8
  s_cbranch_scc0 L_fr_50_s
L_fr_50_o:
  s_lshl_b32 s10, s74, 8
  s_mul_i32 s10, s10, 7168
  s_lshl_b32 s11, s75, 7
  s_add_u32 s10, s10, s11
  s_add_u32 s52, s28, s10
  s_addc_u32 s53, s29, 0
  s_mov_b32 m0, 61440
  v_mov_b32 v48, v19
  v_mov_b32 v49, v20
  v_mov_b32 v50, v19
  v_mov_b32 v51, v20
  v_mov_b32 v52, v19
  v_mov_b32 v53, v20
  v_mov_b32 v54, v19
  v_mov_b32 v55, v20
  s_mov_b32 s87, 57344
  s_mov_b32 s92, 32
  s_getpc_b64 s[88:89]
L_call_60:
  s_add_u32 s88, s88, L_stream-L_call_60
  s_addc_u32 s89, s89, 0
  s_swappc_b64 s[90:91], s[88:89]
  ds_read_b32 v4, v12 offset:8264
  s_waitcnt lgkmcnt(0)
  v_readfirstlane_b32 s15, v4
  s_nop 0
  s_cmp_ge_u32 s15, 8
  s_cbranch_scc1 L_fr_61_o
L_dr_62:
  s_getreg_b32 s85, hwreg(HW_REG_IB_STS, 0, 4)
  s_getreg_b32 s86, hwreg(HW_REG_IB_STS, 22, 2)
  s_lshl_b32 s86, s86, 4
  s_or_b32 s85, s85, s86
  s_cmp_le_u32 s85, 14
  s_cbranch_scc0 L_ph_64
  s_cmp_le_u32 s85, 6
  s_cbranch_scc0 L_ph_65
  s_cmp_le_u32 s85, 2
  s_cbranch_scc0 L_ph_66
  s_waitcnt vmcnt(2)
  s_movk_i32 s14, 2
  s_branch L_pp_63
L_ph_66:
  s_waitcnt vmcnt(6)
  s_movk_i32 s14, 6
  s_branch L_pp_63
L_ph_65:
  s_cmp_le_u32 s85, 10
  s_cbranch_scc0 L_ph_67
  s_waitcnt vmcnt(10)
  s_movk_i32 s14, 10
  s_branch L_pp_63
L_ph_67:
  s_waitcnt vmcnt(14)
  s_movk_i32 s14, 14
  s_branch L_pp_63
L_ph_64:
  s_cmp_le_u32 s85, 24
  s_cbranch_scc0 L_ph_68
  s_cmp_le_u32 s85, 18
  s_cbranch_scc0 L_ph_69
  s_waitcnt vmcnt(18)
  s_movk_i32 s14, 18
  s_branch L_pp_63
L_ph_69:
  s_waitcnt vmcnt(24)
  s_movk_i32 s14, 24
  s_branch L_pp_63
L_ph_68:
  s_cmp_le_u32 s85, 32
  s_cbranch_scc0 L_ph_70
  s_waitcnt vmcnt(32)
  s_movk_i32 s14, 32
  s_branch L_pp_63
L_ph_70:
  s_waitcnt vmcnt(63)
  s_movk_i32 s14, 63
  s_branch L_pp_63
L_pp_63:
  s_sub_u32 s14, s84, s14
  s_max_i32 s14, s14, 0
  v_mov_b32 v35, s14
  s_mov_b64 exec, 1
  ds_write_b32 v12, v35 offset:8192
  s_mov_b64 exec, -1
  s_cmp_gt_u32 s85, 2
  s_cbranch_scc1 L_dr_62
  s_waitcnt vmcnt(0)
  v_mov_b32 v35, s84
  s_mov_b64 exec, 1
  ds_write_b32 v12, v35 offset:8192
  s_mov_b64 exec, -1
  s_mov_b32 s78, 0
L_fr_61_s:
  s_sleep 1
  ds_read_b32 v4, v12 offset:8264
  s_waitcnt lgkmcnt(0)
  v_readfirstlane_b32 s15, v4
  s_add_u32 s78, s78, 1
  s_cmp_gt_u32 s78, 1048576
  s_cbranch_scc1 L_fr_61_o
  s_cmp_ge_u32 s15, 8
  s_cbranch_scc0 L_fr_61_s
L_fr_61_o:
  s_lshr_b32 s10, s75, 0
  s_lshl_b32 s10, s10, 17
  s_and_b32 s11, s82, 3
  s_lshl_b32 s11, s11, 9
  s_add_u32 s10, s10, s11
  s_add_u32 s52, s32, s10
  s_addc_u32 s53, s33, 0
  s_mov_b32 m0, 94208
  v_mov_b32 v48, v31
  v_mov_b32 v49, v32
  v_mov_b32 v50, v31
  v_mov_b32 v51, v32
  v_mov_b32 v52, v33
  v_mov_b32 v53, v34
  v_mov_b32 v54, v33
  v_mov_b32 v55, v34
  s_mov_b32 s87, 4096
  s_mov_b32 s92, 32
  s_getpc_b64 s[88:89]
L_call_71:
  s_add_u32 s88, s88, L_stream-L_call_71
  s_addc_u32 s89, s89, 0
  s_swappc_b64 s[90:91], s[88:89]
L_dr_72:
  s_getreg_b32 s85, hwreg(HW_REG_IB_STS, 0, 4)
  s_getreg_b32 s86, hwreg(HW_REG_IB_STS, 22, 2)
  s_lshl_b32 s86, s86, 4
  s_or_b32 s85, s85, s86
  s_cmp_le_u32 s85, 14
  s_cbranch_scc0 L_ph_74
  s_cmp_le_u32 s85, 6
  s_cbranch_scc0 L_ph_75
  s_cmp_le_u32 s85, 2
  s_cbranch_scc0 L_ph_76
  s_waitcnt vmcnt(2)
  s_movk_i32 s14, 2
  s_branch L_pp_73
L_ph_76:
  s_waitcnt vmcnt(6)
  s_movk_i32 s14, 6
  s_branch L_pp_73
L_ph_75:
  s_cmp_le_u32 s85, 10
  s_cbranch_scc0 L_ph_77
  s_waitcnt vmcnt(10)
  s_movk_i32 s14, 10
  s_branch L_pp_73
L_ph_77:
  s_waitcnt vmcnt(14)
  s_movk_i32 s14, 14
  s_branch L_pp_73
L_ph_74:
  s_cmp_le_u32 s85, 24
  s_cbranch_scc0 L_ph_78
  s_cmp_le_u32 s85, 18
  s_cbranch_scc0 L_ph_79
  s_waitcnt vmcnt(18)
  s_movk_i32 s14, 18
  s_branch L_pp_73
L_ph_79:
  s_waitcnt vmcnt(24)
  s_movk_i32 s14, 24
  s_branch L_pp_73
L_ph_78:
  s_cmp_le_u32 s85, 32
  s_cbranch_scc0 L_ph_80
  s_waitcnt vmcnt(32)
  s_movk_i32 s14, 32
  s_branch L_pp_73
L_ph_80:
  s_waitcnt vmcnt(63)
  s_movk_i32 s14, 63
  s_branch L_pp_73
L_pp_73:
  s_sub_u32 s14, s84, s14
  s_max_i32 s14, s14, 0
  v_mov_b32 v35, s14
  s_mov_b64 exec, 1
  ds_write_b32 v12, v35 offset:8192
  s_mov_b64 exec, -1
  s_cmp_gt_u32 s85, 2
  s_cbranch_scc1 L_dr_72
  s_waitcnt vmcnt(0)
  v_mov_b32 v35, s84
  s_mov_b64 exec, 1
  ds_write_b32 v12, v35 offset:8192
  s_mov_b64 exec, -1
  s_branch L_end
L_stream:
  ds_read_b32 v56, v12 offset:8280
L_stream_loop:
  s_waitcnt lgkmcnt(0)
  v_readfirstlane_b32 s93, v56
  ds_read_b32 v56, v12 offset:8280
  s_movk_i32 s94, 16
  s_cmp_eq_u32 s93, 0
  s_cbranch_scc1 L_py_81
  s_waitcnt vmcnt(3)
  s_movk_i32 s94, 5
L_py_81:
  s_waitcnt vmcnt(15)
  global_load_lds_dwordx4 v48, s[52:53] nt
  s_add_u32 m0, m0, 1024
  s_add_u32 s52, s52, s87
  s_addc_u32 s53, s53, 0
  s_waitcnt vmcnt(15)
  global_load_lds_dwordx4 v49, s[52:53] nt
  s_add_u32 m0, m0, 1024
  s_add_u32 s52, s52, s87
  s_addc_u32 s53, s53, 0
  s_waitcnt lgkmcnt(0)
  v_readfirstlane_b32 s93, v56
  ds_read_b32 v56, v12 offset:8280
  s_movk_i32 s94, 16
  s_cmp_eq_u32 s93, 0
  s_cbranch_scc1 L_py_82
  s_waitcnt vmcnt(3)
  s_movk_i32 s94, 5
L_py_82:
  s_waitcnt vmcnt(15)
  global_load_lds_dwordx4 v50, s[52:53] nt
  s_add_u32 m0, m0, 1024
  s_add_u32 s52, s52, s87
  s_addc_u32 s53, s53, 0
  s_waitcnt vmcnt(15)
  global_load_lds_dwordx4 v51, s[52:53] nt
  s_add_u32 m0, m0, 1024
  s_add_u32 s52, s52, s87
  s_addc_u32 s53, s53, 0
  s_add_u32 s84, s84, 4
  s_sub_u32 s14, s84, s94
  v_mov_b32 v35, s14
  s_mov_b64 exec, 1
  ds_write_b32 v12, v35 offset:8192
  s_mov_b64 exec, -1
  s_waitcnt lgkmcnt(0)
  v_readfirstlane_b32 s93, v56
  ds_read_b32 v56, v12 offset:8280
  s_movk_i32 s94, 16
  s_cmp_eq_u32 s93, 0
  s_cbranch_scc1 L_py_83
  s_waitcnt vmcnt(3)
  s_movk_i32 s94, 5
L_py_83:
  s_waitcnt vmcnt(15)
  global_load_lds_dwordx4 v52, s[52:53] nt
  s_add_u32 m0, m0, 1024
  s_add_u32 s52, s52, s87
  s_addc_u32 s53, s53, 0
  s_waitcnt vmcnt(15)
  global_load_lds_dwordx4 v53, s[52:53] nt
  s_add_u32 m0, m0, 1024
  s_add_u32 s52, s52, s87
  s_addc_u32 s53, s53, 0
  s_waitcnt lgkmcnt(0)
  v_readfirstlane_b32 s93, v56
  ds_read_b32 v56, v12 offset:8280
  s_movk_i32 s94, 16
  s_cmp_eq_u32 s93, 0
  s_cbranch_scc1 L_py_84
  s_waitcnt vmcnt(3)
  s_movk_i32 s94, 5
L_py_84:
  s_waitcnt vmcnt(15)
  global_load_lds_dwordx4 v54, s[52:53] nt
  s_add_u32 m0, m0, 1024
  s_add_u32 s52, s52, s87
  s_addc_u32 s53, s53, 0
  s_waitcnt vmcnt(15)
  global_load_lds_dwordx4 v55, s[52:53] nt
  s_add_u32 m0, m0, 1024
  s_add_u32 s52, s52, s87
  s_addc_u32 s53, s53, 0
  s_add_u32 s84, s84, 4
  s_sub_u32 s14, s84, s94
  v_mov_b32 v35, s14
  s_mov_b64 exec, 1
  ds_write_b32 v12, v35 offset:8192
  s_mov_b64 exec, -1
  s_sub_u32 s92, s92, 8
  s_cmp_gt_u32 s92, 0
  s_cbranch_scc1 L_stream_loop
  s_waitcnt lgkmcnt(0)
  s_setpc_b64 s[90:91]
L_compute:
  v_lshlrev_b32 v13, 4, v0
  v_subrev_u32 v4, 5504, v13
  v_cmp_gt_u32 vcc, 256, v4
  v_mov_b32 v5, 0x7f800000
  s_nop 0
  v_cndmask_b32 v92, -1, v5, vcc
  v_mov_b32 v93, v92
  v_mov_b32 v94, v92
  v_mov_b32 v95, v92
  ds_write_b128 v13, v[92:95]
  s_waitcnt lgkmcnt(0)
  s_load_dword s5, s[44:45], 0
  s_barrier
  v_and_b32 v4, 127, v0
  v_bfe_u32 v5, v0, 7, 1
  v_lshlrev_b32 v6, 11, v5
  v_lshl_add_u32 v6, v4, 1, v6
  s_lshl_b32 s10, s6, 8
  v_add_u32 v6, s10, v6
  global_load_ushort v96, v6, s[36:37]
  v_lshlrev_b32 v7, 3, v0
  global_load_dwordx2 v[98:99], v7, s[16:17]
  v_mul_u32_u24 v101, 272, v5
  v_lshl_add_u32 v101, v4, 1, v101
  s_lshl_b32 s79, s81, 7
  s_lshl_b32 s10, s4, 4
  s_add_u32 s79, s79, s10
  v_and_b32 v32, 1, v3
  v_and_b32 v8, 7, v1
  v_lshlrev_b32 v8, 1, v8
  v_lshrrev_b32 v9, 5, v1
  v_add_u32 v33, v8, v9
  v_add_u32 v8, s79, v33
  v_lshlrev_b32 v8, 1, v8
  v_lshl_add_u32 v8, v32, 11, v8
  global_load_ushort v100, v8, s[16:17]
  s_add_u32 s46, s44, 1048576
  s_addc_u32 s47, s45, 0
  s_mul_i32 s10, s2, 12416
  s_add_u32 s48, s46, s10
  s_addc_u32 s49, s47, 0
  v_bfe_u32 v14, v1, 2, 2
  v_and_b32 v15, 3, v1
  v_lshlrev_b32 v15, 3, v15
  v_lshl_add_u32 v16, v3, 3, v14
  v_lshrrev_b32 v17, 3, v1
  v_lshrrev_b32 v4, 1, v14
  v_and_b32 v5, 1, v3
  v_lshl_or_b32 v4, v5, 1, v4
  s_and_b32 s10, s4, 3
  v_xor_b32 v4, s10, v4
  v_lshl_add_u32 v4, v4, 5, v15
  v_lshl_add_u32 v18, v16, 7, v4
  v_and_b32 v4, 1, v1
  v_lshlrev_b32 v6, 4, v3
  s_movk_i32 s8, 272
  v_mad_u32_u24 v23, v4, s8, v6
  v_lshlrev_b32 v27, 3, v1
  s_mov_b32 s68, 0xbfb8aa3b
  s_mov_b32 s69, 0xb2a57060
  s_mov_b32 s70, 0x3f317218
  s_waitcnt vmcnt(2)
  v_lshlrev_b32 v96, 16, v96
  v_mul_f32 v4, s68, v96
  v_fma_f32 v5, v96, s68, -v4
  v_fma_f32 v5, v96, s69, v5
  v_exp_f32 v4, v4
  s_nop 0
  v_mul_f32 v5, v4, v5
  v_fma_f32 v4, v5, s70, v4
  v_add_f32 v4, 1.0, v4
  v_rcp_f32 v5, v4
  s_nop 0
  v_mul_f32 v6, v96, v5
  v_fma_f32 v7, -v6, v4, v96
  v_fma_f32 v6, v7, v5, v6
  v_cvt_pk_bf16_f32 v6, v6, v6
  ds_write_b16 v101, v6 offset:0
  s_waitcnt vmcnt(0)
  v_lshlrev_b32 v4, 16, v98
  v_and_b32 v5, 0xffff0000, v98
  v_lshlrev_b32 v6, 16, v99
  v_and_b32 v7, 0xffff0000, v99
  v_add_f32 v8, v4, v5
  v_mul_f32 v9, v4, v4
  v_add_f32 v8, v8, v6
  v_fmac_f32 v9, v5, v5
  v_add_f32 v8, v8, v7
  v_fmac_f32 v9, v6, v6
  v_fmac_f32 v9, v7, v7
  s_nop 1
  v_permlane32_swap_b32 v8, v9
  v_add_f32 v8, v8, v9
  v_mov_b32 v10, v8
  s_nop 1
  v_permlane16_swap_b32 v8, v10
  v_add_f32 v8, v8, v10
  s_nop 1
  v_add_f32_dpp v8, v8, v8 row_ror:8 row_mask:0xf bank_mask:0xf
  s_nop 1
  v_add_f32_dpp v8, v8, v8 row_ror:4 row_mask:0xf bank_mask:0xf
  s_nop 1
  v_add_f32_dpp v8, v8, v8 row_ror:2 row_mask:0xf bank_mask:0xf
  s_nop 1
  v_add_f32_dpp v8, v8, v8 row_ror:1 row_mask:0xf bank_mask:0xf
  v_lshrrev_b32 v10, 5, v1
  v_lshlrev_b32 v10, 2, v10
  s_lshl_b32 s10, s4, 3
  v_add_u32 v10, s10, v10
  s_mov_b32 exec_lo, 0x00000001
  s_mov_b32 exec_hi, 0x00000001
  ds_write_b32 v10, v8 offset:6016
  s_mov_b64 exec, -1
  s_lshr_b32 s10, s4, 2
  s_lshl_b32 s10, s10, 14
  s_add_u32 s10, s10, 61440
  v_add_u32 v19, s10, v18
  v_and_b32 v5, 1, v3
  v_lshl_or_b32 v6, v5, 2, v14
  v_xor_b32 v4, s4, v6
  v_lshl_add_u32 v4, v4, 5, v15
  v_lshl_add_u32 v20, v16, 8, v4
  v_add_u32 v21, 94208, v20
  v_add_u32 v20, 28672, v20
  s_lshl_b32 s10, s4, 1
  v_xor_b32 v4, s10, v6
  v_lshl_add_u32 v4, v4, 5, v15
  v_lshl_add_u32 v22, v16, 9, v4
  v_and_b32 v4, 1, v1
  v_lshlrev_b32 v5, 4, v3
  s_movk_i32 s8, 272
  v_and_b32 v6, 7, v1
  v_mad_u32_u24 v24, v6, s8, v5
  s_movk_i32 s8, 144
  v_mad_u32_u24 v25, v4, s8, v5
  s_movk_i32 s8, 528
  v_mad_u32_u24 v26, v4, s8, v5
  s_lshr_b32 s10, s4, 2
  s_lshl_b32 s10, s10, 8
  v_add_u32 v26, s10, v26
  v_xor_b32 v4, v3, v2
  v_lshlrev_b32 v4, 4, v4
  v_lshl_add_u32 v29, v2, 8, v4
  s_lshl_b32 s10, s4, 12
  s_add_u32 s10, s10, 61440
  v_add_u32 v29, s10, v29
  v_lshlrev_b32 v11, 5, v32
  s_mov_b32 s78, 0
L_ST_lr:
  ds_read_b128 v[52:55], v11 offset:6016
  ds_read_b128 v[56:59], v11 offset:6032
  s_waitcnt lgkmcnt(0)
  v_add_f32 v4, v52, v54
  v_add_f32 v5, v53, v55
  v_add_f32 v4, v4, v56
  v_add_f32 v5, v5, v57
  v_add_f32 v4, v4, v58
  v_add_f32 v5, v5, v59
  v_cmp_u_f32 vcc, v4, v5
  s_cbranch_vccz L_ST_lo
  s_add_u32 s78, s78, 1
  s_cmp_lt_u32 s78, 131072
  s_cbranch_scc1 L_ST_lr
L_ST_lo:
  s_nop 0
  v_mul_f32 v4, 0x3a800000, v4
  v_mul_f32 v5, 0x3a800000, v5
  v_fma_f32 v5, -v4, v4, v5
  v_cvt_pk_bf16_f32 v6, v4, v4
  v_lshlrev_b32 v6, 16, v6
  v_cvt_pk_bf16_f32 v8, v5, v5
  v_lshlrev_b32 v8, 16, v8
  v_add_f32 v8, 0x3727c5ac, v8
  v_cvt_pk_bf16_f32 v8, v8, v8
  v_lshlrev_b32 v8, 16, v8
  v_sqrt_f32 v8, v8
  s_nop 0
  v_cvt_pk_bf16_f32 v7, v8, v8
  v_lshlrev_b32 v7, 16, v7
  v_lshlrev_b32 v100, 16, v100
  v_sub_f32 v8, v100, v6
  v_cvt_pk_bf16_f32 v8, v8, v8
  v_lshlrev_b32 v8, 16, v8
  v_rcp_f32 v9, v7
  s_nop 0
  v_mul_f32 v10, v8, v9
  v_fma_f32 v11, -v10, v7, v8
  v_fma_f32 v10, v11, v9, v10
  v_cvt_pk_bf16_f32 v30, v10, v10
  v_lshlrev_b32 v30, 16, v30
  s_waitcnt lgkmcnt(0)
  s_mul_i32 s5, s5, 1664525
  s_add_u32 s5, s5, 1013904223
  s_lshr_b32 s10, s4, 2
  s_lshl_b32 s10, s10, 3
  s_add_u32 s10, s10, s81
  v_and_b32 v4, 7, v1
  v_lshlrev_b32 v7, 5, v4
  v_bfe_u32 v5, v1, 3, 1
  v_lshl_add_u32 v5, v5, 4, v7
  v_add_u32 v5, s10, v5
  s_and_b32 s11, s81, 3
  s_lshl_b32 s11, s11, 3
  s_add_u32 s11, s11, s4
  s_lshl_b32 s11, s11, 3
  v_add_u32 v6, s11, v4
  v_cmp_gt_u32 vcc, 16, v1
  s_nop 1
  v_cndmask_b32 v5, v6, v5, vcc
  v_lshlrev_b32 v92, 7, v5
  v_add_u32 v92, 131072, v92
  v_lshlrev_b32 v4, 5, v17
  v_add_u32 v4, s10, v4
  s_mov_b32 s8, 12416
  v_mul_lo_u32 v93, v4, s8
  v_and_b32 v5, 7, v1
  v_lshl_add_u32 v93, v5, 4, v93
  s_and_b32 s11, s4, 3
  s_lshl_b32 s11, s11, 7
  v_add_u32 v93, s11, v93
  s_add_u32 s26, s46, 198656
  s_addc_u32 s27, s47, 0
  v_mul_u32_u24 v94, 272, v32
  v_lshl_add_u32 v94, v33, 1, v94
  s_lshl_b32 s11, s4, 5
  v_add_u32 v94, s11, v94
  v_lshlrev_b32 v95, 9, v2
  v_lshl_add_u32 v95, v3, 4, v95
  s_lshl_b32 s11, s4, 6
  v_add_u32 v95, s11, v95
  s_and_b32 s11, s81, 3
  s_lshl_b32 s11, s11, 3
  s_add_u32 s11, s11, s4
  s_lshl_b32 s11, s11, 3
  v_lshrrev_b32 v4, 5, v1
  v_add_u32 v4, s11, v4
  s_mov_b32 s8, 12416
  v_mul_lo_u32 v100, v4, s8
  v_bfe_u32 v5, v1, 2, 3
  v_and_b32 v6, 3, v1
  v_and_b32 v7, 31, v1
  v_lshl_add_u32 v100, v7, 4, v100
  s_lshr_b32 s11, s81, 2
  s_lshl_b32 s11, s11, 9
  s_add_u32 s11, s11, 512
  v_add_u32 v100, s11, v100
  s_add_u32 s56, s46, 24832
  s_addc_u32 s57, s47, 0
  s_add_u32 s58, s46, 49664
  s_addc_u32 s59, s47, 0
  s_add_u32 s60, s46, 74496
  s_addc_u32 s61, s47, 0
  v_lshlrev_b32 v101, 5, v5
  v_lshl_add_u32 v101, v6, 3, v101
  v_lshrrev_b32 v5, 5, v1
  v_lshl_add_u32 v101, v5, 2, v101
  s_mul_i32 s11, s4, 272
  v_add_u32 v101, s11, v101
  v_lshlrev_b32 v102, 5, v2
  s_lshl_b32 s11, s4, 2
  v_add_u32 v102, s11, v102
  v_and_b32 v103, 7, v1
  v_lshlrev_b32 v103, 5, v103
  v_mul_u32_u24 v104, 272, v2
  v_lshl_add_u32 v104, v3, 3, v104
  s_lshl_b32 s11, s4, 5
  v_add_u32 v104, s11, v104
  v_lshlrev_b32 v105, 9, v2
  v_lshl_add_u32 v105, v3, 4, v105
  s_lshl_b32 s11, s4, 6
  s_add_u32 s11, s11, 7680
  v_add_u32 v105, s11, v105
  s_cmp_lt_u32 s4, 4
  s_cbranch_scc0 L_A_done
  s_mov_b32 s78, 0
L_wf_1:
  ds_read_b32 v31, v12 offset:8192
  s_waitcnt lgkmcnt(0)
  v_readfirstlane_b32 s15, v31
  s_nop 0
  s_cmp_ge_u32 s15, 18
  s_cbranch_scc1 L_wf_1_o
  s_add_u32 s78, s78, 1
  s_cmp_lt_u32 s78, 1048576
  s_cbranch_scc1 L_wf_1
L_wf_1_o:
  ds_read_b64_tr_b16 v[36:37], v18 offset:12288
  ds_read_b64_tr_b16 v[38:39], v18 offset:12800
  ds_read_b64_tr_b16 v[40:41], v18 offset:16384
  ds_read_b64_tr_b16 v[42:43], v18 offset:16896
  ds_read_b64_tr_b16 v[44:45], v18 offset:20480
  ds_read_b64_tr_b16 v[46:47], v18 offset:20992
  ds_read_b64_tr_b16 v[48:49], v18 offset:24576
  ds_read_b64_tr_b16 v[50:51], v18 offset:25088
  s_mov_b32 s78, 0
L_A_lr:
  ds_read_b128 v[52:55], v23 offset:0
  ds_read_b128 v[56:59], v23 offset:64
  ds_read_b128 v[60:63], v23 offset:128
  ds_read_b128 v[64:67], v23 offset:192
  s_waitcnt lgkmcnt(0)
  v_mfma_f32_16x16x32_bf16 v[68:71], v[52:55], v[36:39], 0
  v_mfma_f32_16x16x32_bf16 v[68:71], v[56:59], v[40:43], v[68:71]
  v_mfma_f32_16x16x32_bf16 v[68:71], v[60:63], v[44:47], v[68:71]
  v_mfma_f32_16x16x32_bf16 v[68:71], v[64:67], v[48:51], v[68:71]
  s_nop 7
  v_cmp_u_f32 vcc, v68, v69
  s_cbranch_vccz L_A_lo
  s_add_u32 s78, s78, 1
  s_cmp_lt_u32 s78, 131072
  s_cbranch_scc1 L_A_lr
L_A_lo:
  s_nop 0
  s_mov_b32 s78, 0
L_wf_2:
  ds_read_b32 v31, v12 offset:8192
  s_waitcnt lgkmcnt(0)
  v_readfirstlane_b32 s15, v31
  s_nop 0
  s_cmp_ge_u32 s15, 28
  s_cbranch_scc1 L_wf_2_o
  s_add_u32 s78, s78, 1
  s_cmp_lt_u32 s78, 1048576
  s_cbranch_scc1 L_wf_2
L_wf_2_o:
  s_lshl_b32 s10, s4, 7
  v_add_u32 v4, s10, v27
  s_mov_b64 exec, 0x0000ffff
  global_store_dwordx2 v4, v[68:69], s[48:49] offset:0 sc1
  s_mov_b64 exec, -1
L_A_done:
  s_nop 0
  s_mov_b32 s78, 0
L_wf_3:
  ds_read_b32 v31, v12 offset:8192
  s_waitcnt lgkmcnt(0)
  v_readfirstlane_b32 s15, v31
  s_nop 0
  s_cmp_ge_u32 s15, 40
  s_cbranch_scc1 L_wf_3_o
  s_sleep 1
  s_add_u32 s78, s78, 1
  s_cmp_lt_u32 s78, 1048576
  s_cbranch_scc1 L_wf_3
L_wf_3_o:
  s_mov_b32 s12, 0
  global_load_dwordx2 v[96:97], v92, s[44:45] sc1
  s_cmp_eq_u32 s4, 0
  s_cbranch_scc0 L_sp_4
  v_mov_b32 v31, 0
  s_mov_b64 exec, 1
  ds_write_b32 v12, v31 offset:8280
  s_mov_b64 exec, -1
L_sp_4:
  s_waitcnt vmcnt(0)
L_FL_consume:
  v_cmp_ne_u32 vcc, s5, v96
  s_cbranch_vccz L_FL_ok
  s_add_u32 s12, s12, 1
  s_cmp_gt_u32 s12, 16384
  s_cbranch_scc1 L_FL_ok
  s_sleep 3
  global_load_dwordx2 v[96:97], v92, s[44:45] sc1
  s_waitcnt vmcnt(0)
  s_branch L_FL_consume
L_FL_ok:
  s_nop 0
  s_mov_b32 s78, 0
L_wf_5:
  ds_read_b32 v31, v12 offset:8192
  s_waitcnt lgkmcnt(0)
  v_readfirstlane_b32 s15, v31
  s_nop 0
  s_cmp_ge_u32 s15, 32
  s_cbranch_scc1 L_wf_5_o
  s_sleep 1
  s_add_u32 s78, s78, 1
  s_cmp_lt_u32 s78, 1048576
  s_cbranch_scc1 L_wf_5
L_wf_5_o:
  s_mov_b32 s12, 0
  global_load_dwordx4 v[76:79], v93, s[46:47] offset:0 sc1
  global_load_dwordx4 v[80:83], v93, s[26:27] offset:0 sc1
  s_cmp_eq_u32 s4, 0
  s_cbranch_scc0 L_sp_6
  v_mov_b32 v31, 0
  s_mov_b64 exec, 1
  ds_write_b32 v12, v31 offset:8280
  s_mov_b64 exec, -1
L_sp_6:
  s_mov_b32 s78, 0
L_wf_7:
  ds_read_b32 v31, v12 offset:8192
  s_waitcnt lgkmcnt(0)
  v_readfirstlane_b32 s15, v31
  s_nop 0
  s_cmp_ge_u32 s15, 60
  s_cbranch_scc1 L_wf_7_o
  s_sleep 1
  s_add_u32 s78, s78, 1
  s_cmp_lt_u32 s78, 1048576
  s_cbranch_scc1 L_wf_7
L_wf_7_o:
  ds_read_b64_tr_b16 v[36:37], v20 offset:0
  ds_read_b64_tr_b16 v[38:39], v20 offset:1024
  ds_read_b64_tr_b16 v[40:41], v20 offset:8192
  ds_read_b64_tr_b16 v[42:43], v20 offset:9216
  ds_read_b64_tr_b16 v[44:45], v20 offset:16384
  ds_read_b64_tr_b16 v[46:47], v20 offset:17408
  ds_read_b64_tr_b16 v[48:49], v20 offset:24576
  ds_read_b64_tr_b16 v[50:51], v20 offset:25600
  s_waitcnt lgkmcnt(0)
  v_mov_b32 v31, 1
  s_mov_b64 exec, 1
  ds_add_u32 v12, v31 offset:8256
  s_mov_b64 exec, -1
  s_waitcnt vmcnt(0)
L_G1_consume:
  v_permlane32_swap_b32 v76, v78
  v_permlane32_swap_b32 v77, v79
  v_add_f32 v76, v76, v78
  v_add_f32 v77, v77, v79
  s_nop 1
  v_permlane16_swap_b32 v76, v77
  v_add_f32 v98, v76, v77
  v_permlane32_swap_b32 v80, v82
  v_permlane32_swap_b32 v81, v83
  v_add_f32 v80, v80, v82
  v_add_f32 v81, v81, v83
  s_nop 1
  v_permlane16_swap_b32 v80, v81
  v_add_f32 v99, v80, v81
  v_add_f32_dpp v98, v98, v98 row_ror:8 row_mask:0xf bank_mask:0xf
  s_nop 0
  v_add_f32_dpp v99, v99, v99 row_ror:8 row_mask:0xf bank_mask:0xf
  v_cmp_u_f32 vcc, v98, v99
  s_cbranch_vccz L_G1_ok
  s_add_u32 s12, s12, 1
  s_cmp_gt_u32 s12, 16384
  s_cbranch_scc1 L_G1_ok
  s_sleep 3
  global_load_dwordx4 v[76:79], v93, s[46:47] offset:0 sc1
  global_load_dwordx4 v[80:83], v93, s[26:27] offset:0 sc1
  s_waitcnt vmcnt(0)
  s_branch L_G1_consume
L_G1_ok:
  s_nop 0
  v_cvt_pk_bf16_f32 v4, v98, v99
  v_and_b32 v5, 0xffff0000, v4
  v_lshlrev_b32 v4, 16, v4
  v_add_f32 v5, 1.0, v5
  v_cvt_pk_bf16_f32 v5, v5, v5
  v_lshlrev_b32 v5, 16, v5
  v_mul_f32 v5, v30, v5
  v_cvt_pk_bf16_f32 v5, v5, v5
  v_lshlrev_b32 v5, 16, v5
  v_add_f32 v5, v5, v4
  v_cvt_pk_bf16_f32 v5, v5, v5
  ds_write_b16 v94, v5 offset:576
  s_mov_b32 s78, 0
L_Q_lr:
  ds_read_b128 v[52:55], v23 offset:576
  ds_read_b128 v[56:59], v23 offset:640
  ds_read_b128 v[60:63], v23 offset:704
  ds_read_b128 v[64:67], v23 offset:768
  s_waitcnt lgkmcnt(0)
  v_mfma_f32_16x16x32_bf16 v[68:71], v[36:39], v[52:55], 0
  v_mfma_f32_16x16x32_bf16 v[68:71], v[40:43], v[56:59], v[68:71]
  v_mfma_f32_16x16x32_bf16 v[68:71], v[44:47], v[60:63], v[68:71]
  v_mfma_f32_16x16x32_bf16 v[68:71], v[48:51], v[64:67], v[68:71]
  s_nop 7
  v_cmp_u_f32 vcc, v68, v71
  s_cbranch_vccz L_Q_lo
  s_add_u32 s78, s78, 1
  s_cmp_lt_u32 s78, 131072
  s_cbranch_scc1 L_Q_lr
L_Q_lo:
  s_nop 0
  s_mov_b32 exec_lo, 0x00030003
  s_mov_b32 exec_hi, 0x00030003
  global_store_dwordx4 v95, v[68:71], s[48:49] offset:512 sc1
  s_mov_b64 exec, -1
  s_lshr_b32 s10, s83, 3
  s_lshr_b32 s11, s10, 3
  s_bfe_u32 s14, s4, 0x10001
  s_lshl_b32 s14, s14, 2
  s_add_u32 s11, s11, s14
  s_and_b32 s10, s10, 7
  s_mov_b32 s8, 12416
  v_lshlrev_b32 v4, 3, v17
  v_add_u32 v4, s11, v4
  v_mul_lo_u32 v106, v4, s8
  s_lshl_b32 s15, s10, 9
  s_add_u32 s15, s15, 7680
  s_bfe_u32 s13, s83, 0x10002
  s_lshl_b32 s13, s13, 8
  s_add_u32 s15, s15, s13
  s_and_b32 s13, s4, 1
  s_lshl_b32 s13, s13, 7
  s_add_u32 s15, s15, s13
  v_and_b32 v5, 7, v1
  v_lshl_add_u32 v106, v5, 4, v106
  v_add_u32 v106, s15, v106
  s_lshl_b32 s14, s10, 3
  s_add_u32 s14, s14, 11776
  v_and_b32 v4, 31, v1
  v_lshlrev_b32 v4, 3, v4
  v_add_u32 v4, s11, v4
  v_mul_lo_u32 v4, v4, s8
  v_add_u32 v107, s14, v4
  s_add_u32 s62, s46, 794624
  s_addc_u32 s63, s47, 0
  s_add_u32 s64, s46, 1589248
  s_addc_u32 s65, s47, 0
  s_add_u32 s66, s46, 2383872
  s_addc_u32 s67, s47, 0
  v_lshlrev_b32 v108, 2, v17
  v_lshl_add_u32 v116, v5, 2, v3
  v_lshlrev_b32 v116, 1, v116
  s_bfe_u32 s14, s4, 0x10001
  s_mul_i32 s14, s14, 144
  s_and_b32 s13, s4, 1
  s_lshl_b32 s13, s13, 6
  s_add_u32 s14, s14, s13
  v_add_u32 v116, s14, v116
  v_add_u32 v117, 126976, v22
  v_xor_b32 v118, 32, v117
  s_lshl_b32 s11, s4, 8
  v_add_u32 v28, s11, v27
  s_mov_b32 s78, 0
L_wf_8:
  ds_read_b32 v31, v12 offset:8192
  s_waitcnt lgkmcnt(0)
  v_readfirstlane_b32 s15, v31
  s_nop 0
  s_cmp_ge_u32 s15, 82
  s_cbranch_scc1 L_wf_8_o
  s_sleep 1
  s_add_u32 s78, s78, 1
  s_cmp_lt_u32 s78, 1048576
  s_cbranch_scc1 L_wf_8
L_wf_8_o:
  s_sleep 6
  s_cmp_eq_u32 s4, 0
  s_cbranch_scc0 L_sp_9
  v_mov_b32 v31, 1
  s_mov_b64 exec, 1
  ds_write_b32 v12, v31 offset:8280
  s_mov_b64 exec, -1
L_sp_9:
  s_sleep 12
  s_mov_b32 s12, 0
  global_load_dwordx4 v[76:79], v100, s[46:47] sc1
  global_load_dwordx4 v[80:83], v100, s[56:57] sc1
  global_load_dwordx4 v[84:87], v100, s[58:59] sc1
  global_load_dwordx4 v[88:91], v100, s[60:61] sc1
  s_cmp_eq_u32 s4, 0
  s_cbranch_scc0 L_sp_10
  v_mov_b32 v31, 0
  s_mov_b64 exec, 1
  ds_write_b32 v12, v31 offset:8280
  s_mov_b64 exec, -1
L_sp_10:
  s_mov_b32 s78, 0
L_wf_11:
  ds_read_b32 v31, v12 offset:8192
  s_waitcnt lgkmcnt(0)
  v_readfirstlane_b32 s15, v31
  s_nop 0
  s_cmp_ge_u32 s15, 92
  s_cbranch_scc1 L_wf_11_o
  s_sleep 1
  s_add_u32 s78, s78, 1
  s_cmp_lt_u32 s78, 1048576
  s_cbranch_scc1 L_wf_11
L_wf_11_o:
  ds_read_b128 v[36:39], v29
  v_xor_b32 v5, 64, v29
  ds_read_b128 v[40:43], v5
  v_xor_b32 v6, 128, v29
  ds_read_b128 v[44:47], v6
  v_xor_b32 v7, 192, v29
  ds_read_b128 v[48:51], v7
  s_waitcnt lgkmcnt(0)
  v_mov_b32 v31, 1
  s_mov_b64 exec, 1
  ds_add_u32 v12, v31 offset:8260
  s_mov_b64 exec, -1
  s_waitcnt vmcnt(0)
L_G2_consume:
  v_add_f32 v76, v76, v80
  v_add_f32 v84, v84, v88
  v_add_f32 v77, v77, v81
  v_add_f32 v85, v85, v89
  v_add_f32 v78, v78, v82
  v_add_f32 v86, v86, v90
  v_add_f32 v79, v79, v83
  v_add_f32 v87, v87, v91
  v_add_f32 v76, v76, v84
  v_add_f32 v77, v77, v85
  v_add_f32 v78, v78, v86
  v_add_f32 v79, v79, v87
  s_nop 0
  v_permlane32_swap_b32 v76, v78
  v_permlane32_swap_b32 v77, v79
  v_add_f32 v76, v76, v78
  v_add_f32 v77, v77, v79
  v_cmp_u_f32 vcc, v76, v77
  s_cbranch_vccz L_G2_ok
  s_add_u32 s12, s12, 1
  s_cmp_gt_u32 s12, 16384
  s_cbranch_scc1 L_G2_ok
  s_sleep 3
  global_load_dwordx4 v[76:79], v100, s[46:47] sc1
  global_load_dwordx4 v[80:83], v100, s[56:57] sc1
  global_load_dwordx4 v[84:87], v100, s[58:59] sc1
  global_load_dwordx4 v[88:91], v100, s[60:61] sc1
  s_waitcnt vmcnt(0)
  s_branch L_G2_consume
L_G2_ok:
  s_nop 0
  v_cvt_pk_bf16_f32 v4, v76, v77
  ds_write_b32 v101, v4 offset:1152
  s_mov_b32 s78, 0
L_SC_lr:
  ds_read_b128 v[52:55], v24 offset:1152
  ds_read_b128 v[56:59], v24 offset:1216
  ds_read_b128 v[60:63], v24 offset:1280
  ds_read_b128 v[64:67], v24 offset:1344
  s_waitcnt lgkmcnt(0)
  v_mfma_f32_16x16x32_bf16 v[68:71], v[36:39], v[52:55], 0
  v_mfma_f32_16x16x32_bf16 v[68:71], v[40:43], v[56:59], v[68:71]
  v_mfma_f32_16x16x32_bf16 v[68:71], v[44:47], v[60:63], v[68:71]
  v_mfma_f32_16x16x32_bf16 v[68:71], v[48:51], v[64:67], v[68:71]
  s_nop 7
  v_cmp_u_f32 vcc, v68, v69
  s_cbranch_vccz L_SC_lo
  s_add_u32 s78, s78, 1
  s_cmp_lt_u32 s78, 131072
  s_cbranch_scc1 L_SC_lr
L_SC_lo:
  s_nop 0
  s_mov_b32 s68, 0x3db504f3
  v_cvt_pk_bf16_f32 v8, v68, v69
  v_cvt_pk_bf16_f32 v9, v70, v71
  v_lshlrev_b32 v119, 16, v8
  v_and_b32 v120, 0xffff0000, v8
  v_lshlrev_b32 v121, 16, v9
  v_and_b32 v122, 0xffff0000, v9
  v_mul_f32 v119, s68, v119
  v_mul_f32 v120, s68, v120
  v_mul_f32 v121, s68, v121
  v_mul_f32 v122, s68, v122
  v_cvt_pk_bf16_f32 v8, v119, v120
  v_cvt_pk_bf16_f32 v9, v121, v122
  v_lshlrev_b32 v119, 16, v8
  v_and_b32 v120, 0xffff0000, v8
  v_lshlrev_b32 v121, 16, v9
  v_and_b32 v122, 0xffff0000, v9
  v_max3_f32 v8, v119, v120, v121
  v_max_f32 v8, v8, v122
  v_mov_b32 v9, v8
  s_nop 1
  v_permlane16_swap_b32 v8, v9
  v_max_f32 v8, v8, v9
  v_mov_b32 v9, v8
  s_nop 1
  v_permlane32_swap_b32 v8, v9
  v_max_f32 v8, v8, v9
  s_mov_b64 exec, 0x000000ff
  ds_write_b32 v102, v8 offset:5504
  s_mov_b64 exec, -1
  s_mov_b32 s78, 0
L_wf_12:
  ds_read_b32 v31, v12 offset:8192
  s_waitcnt lgkmcnt(0)
  v_readfirstlane_b32 s15, v31
  s_nop 0
  s_cmp_ge_u32 s15, 124
  s_cbranch_scc1 L_wf_12_o
  s_sleep 1
  s_add_u32 s78, s78, 1
  s_cmp_lt_u32 s78, 1048576
  s_cbranch_scc1 L_wf_12
L_wf_12_o:
  ds_read_b64_tr_b16 v[124:125], v21 offset:0
  ds_read_b64_tr_b16 v[126:127], v21 offset:1024
  ds_read_b64_tr_b16 v[128:129], v21 offset:8192
  ds_read_b64_tr_b16 v[130:131], v21 offset:9216
  ds_read_b64_tr_b16 v[132:133], v21 offset:16384
  ds_read_b64_tr_b16 v[134:135], v21 offset:17408
  ds_read_b64_tr_b16 v[136:137], v21 offset:24576
  ds_read_b64_tr_b16 v[138:139], v21 offset:25600
  s_mov_b32 s78, 0
L_MX_lr:
  ds_read_b128 v[52:55], v103 offset:5504
  ds_read_b128 v[56:59], v103 offset:5520
  s_waitcnt lgkmcnt(0)
  v_max3_f32 v8, v52, v53, v54
  v_max3_f32 v9, v55, v56, v57
  v_max3_f32 v8, v8, v58, v59
  v_max_f32 v140, v8, v9
  v_cmp_eq_u32 vcc, 0x7f800000, v140
  s_cbranch_vccz L_MX_lo
  s_add_u32 s78, s78, 1
  s_cmp_lt_u32 s78, 131072
  s_cbranch_scc1 L_MX_lr
L_MX_lo:
  s_nop 0
  v_mov_b32 v31, 1
  s_mov_b64 exec, 1
  ds_add_u32 v12, v31 offset:8264
  s_mov_b64 exec, -1
  s_mov_b32 s68, 0x3fb8aa3b
  v_sub_f32 v119, v119, v140
  v_sub_f32 v120, v120, v140
  v_sub_f32 v121, v121, v140
  v_sub_f32 v122, v122, v140
  v_mul_f32 v119, s68, v119
  v_mul_f32 v120, s68, v120
  v_mul_f32 v121, s68, v121
  v_mul_f32 v122, s68, v122
  v_exp_f32 v119, v119
  v_exp_f32 v120, v120
  v_exp_f32 v121, v121
  v_exp_f32 v122, v122
  v_cvt_pk_bf16_f32 v52, v119, v120
  v_cvt_pk_bf16_f32 v53, v121, v122
  s_mov_b32 exec_lo, 0x00ff00ff
  s_mov_b32 exec_hi, 0x00ff00ff
  ds_write_b64 v104, v[52:53] offset:3328
  s_mov_b64 exec, -1
  v_add_f32 v8, v119, v120
  v_add_f32 v9, v121, v122
  v_add_f32 v8, v8, v9
  v_mov_b32 v9, v8
  s_nop 1
  v_permlane16_swap_b32 v8, v9
  v_add_f32 v8, v8, v9
  v_mov_b32 v9, v8
  s_nop 1
  v_permlane32_swap_b32 v8, v9
  v_add_f32 v8, v8, v9
  s_mov_b64 exec, 0x000000ff
  ds_write_b32 v102, v8 offset:5760
  s_mov_b64 exec, -1
  s_mov_b32 s78, 0
L_PV_lr:
  ds_read_b128 v[52:55], v24 offset:3328
  ds_read_b128 v[56:59], v24 offset:3392
  ds_read_b128 v[60:63], v24 offset:3456
  ds_read_b128 v[64:67], v24 offset:3520
  s_waitcnt lgkmcnt(0)
  v_mfma_f32_16x16x32_bf16 v[68:71], v[124:127], v[52:55], 0
  v_mfma_f32_16x16x32_bf16 v[68:71], v[128:131], v[56:59], v[68:71]
  v_mfma_f32_16x16x32_bf16 v[68:71], v[132:135], v[60:63], v[68:71]
  v_mfma_f32_16x16x32_bf16 v[68:71], v[136:139], v[64:67], v[68:71]
  s_nop 7
  v_cmp_u_f32 vcc, v68, v69
  s_cbranch_vccz L_PV_lo
  s_add_u32 s78, s78, 1
  s_cmp_lt_u32 s78, 131072
  s_cbranch_scc1 L_PV_lr
L_PV_lo:
  s_nop 0
  s_mov_b32 exec_lo, 0x00ff00ff
  s_mov_b32 exec_hi, 0x00ff00ff
  global_store_dwordx4 v105, v[68:71], s[48:49] sc1
  s_mov_b64 exec, -1
  s_cmp_eq_u32 s4, 0
  s_cbranch_scc0 L_S_nost
  s_mov_b32 s78, 0
L_LS_lr:
  ds_read_b128 v[36:39], v103 offset:5760
  ds_read_b128 v[40:43], v103 offset:5776
  s_waitcnt lgkmcnt(0)
  v_add_f32 v4, v36, v37
  v_add_f32 v5, v38, v39
  v_add_f32 v6, v40, v41
  v_add_f32 v7, v42, v43
  v_add_f32 v4, v4, v5
  v_add_f32 v6, v6, v7
  v_add_f32 v73, v4, v6
  v_cmp_u_f32 vcc, v73, v73
  s_cbranch_vccz L_LS_lo
  s_add_u32 s78, s78, 1
  s_cmp_lt_u32 s78, 131072
  s_cbranch_scc1 L_LS_lr
L_LS_lo:
  s_nop 0
  v_mov_b32 v72, v140
  v_add_u32 v4, 11776, v27
  s_mov_b64 exec, 0x000000ff
  global_store_dwordx2 v4, v[72:73], s[48:49] sc1
  s_mov_b64 exec, -1
L_S_nost:
  s_cmp_lt_u32 s2, 224
  s_cbranch_scc1 L_skipR1
  s_sub_u32 s73, s2, 224
  v_mov_b32 v36, -1
  v_mov_b32 v37, -1
  v_mov_b32 v38, -1
  v_mov_b32 v39, -1
  v_cmp_gt_u32 vcc, 384, v0
  s_nop 0
  s_and_saveexec_b64 s[8:9], vcc
  ds_write_b128 v13, v[36:39] offset:12288
  s_mov_b64 exec, s[8:9]
  s_waitcnt lgkmcnt(0)
  v_mov_b32 v31, 1
  s_mov_b64 exec, 1
  ds_add_u32 v12, v31 offset:8272
  s_mov_b64 exec, -1
  s_lshr_b32 s10, s4, 1
  s_lshl_b32 s10, s10, 3
  s_lshr_b32 s11, s73, 2
  s_add_u32 s10, s10, s11
  s_and_b32 s11, s4, 1
  s_lshl_b32 s11, s11, 7
  s_add_u32 s10, s10, s11
  v_lshlrev_b32 v4, 5, v3
  v_add_u32 v4, s10, v4
  s_mov_b32 s8, 12416
  v_mul_lo_u32 v141, v4, s8
  v_lshl_add_u32 v141, v2, 4, v141
  s_and_b32 s11, s73, 3
  s_lshl_b32 s11, s11, 8
  s_add_u32 s11, s11, 1536
  v_add_u32 v141, s11, v141
  v_lshl_add_u32 v142, v2, 2, v3
  v_lshlrev_b32 v142, 2, v142
  s_lshl_b32 s11, s4, 8
  v_add_u32 v142, s11, v142
  v_and_b32 v4, 31, v1
  s_lshl_b32 s11, s73, 5
  v_add_u32 v4, s11, v4
  v_lshlrev_b32 v4, 1, v4
  global_load_ushort v145, v4, s[34:35]
  v_lshrrev_b32 v5, 5, v1
  v_lshl_add_u32 v147, v5, 11, v4
  global_load_ushort v144, v147, s[16:17]
  v_and_b32 v4, 31, v1
  v_lshlrev_b32 v146, 3, v4
  v_lshl_add_u32 v146, v5, 2, v146
  v_lshlrev_b32 v148, 2, v1
  v_add_u32 v148, 4608, v148
  s_lshr_b32 s11, s73, 3
  s_lshl_b32 s10, s11, 3
  s_add_u32 s10, s10, s4
  v_lshlrev_b32 v4, 5, v3
  v_add_u32 v4, s10, v4
  v_mul_lo_u32 v149, v4, s8
  s_lshl_b32 s10, s4, 2
  s_add_u32 s10, s10, s11
  s_lshl_b32 s10, s10, 3
  v_add_u32 v4, s10, v3
  v_mul_lo_u32 v150, v4, s8
  s_and_b32 s11, s73, 7
  s_lshl_b32 s11, s11, 8
  v_lshlrev_b32 v5, 4, v2
  v_add_u32 v5, s11, v5
  v_add_u32 v149, v149, v5
  v_add_u32 v150, v150, v5
  v_add_u32 v150, 5632, v150
  v_add_u32 v149, 2560, v149
  s_add_u32 s26, s46, 1589248
  s_addc_u32 s27, s47, 0
  s_add_u32 s52, s46, 49664
  s_addc_u32 s53, s47, 0
L_skipR1:
  s_nop 1
  s_cmp_lt_u32 s4, 4
  s_cbranch_scc0 L_O_nog
  s_mov_b32 s78, 0
L_wf_13:
  ds_read_b32 v31, v12 offset:8192
  s_waitcnt lgkmcnt(0)
  v_readfirstlane_b32 s15, v31
  s_nop 0
  s_cmp_ge_u32 s15, 136
  s_cbranch_scc1 L_wf_13_o
  s_sleep 1
  s_add_u32 s78, s78, 1
  s_cmp_lt_u32 s78, 1048576
  s_cbranch_scc1 L_wf_13
L_wf_13_o:
  s_sleep 30
  s_cmp_eq_u32 s4, 0
  s_cbranch_scc0 L_sp_14
  v_mov_b32 v31, 1
  s_mov_b64 exec, 1
  ds_write_b32 v12, v31 offset:8280
  s_mov_b64 exec, -1
L_sp_14:
  s_sleep 12
  s_mov_b32 s12, 0
  global_load_dwordx2 v[114:115], v107, s[46:47] sc1
  global_load_dwordx4 v[76:79], v106, s[46:47] sc1
  global_load_dwordx4 v[80:83], v106, s[62:63] sc1
  global_load_dwordx4 v[84:87], v106, s[64:65] sc1
  global_load_dwordx4 v[88:91], v106, s[66:67] sc1
  s_cmp_eq_u32 s4, 0
  s_cbranch_scc0 L_sp_15
  v_mov_b32 v31, 0
  s_mov_b64 exec, 1
  ds_write_b32 v12, v31 offset:8280
  s_mov_b64 exec, -1
L_sp_15:
  s_mov_b32 s78, 0
L_wf_16:
  ds_read_b32 v31, v12 offset:8192
  s_waitcnt lgkmcnt(0)
  v_readfirstlane_b32 s15, v31
  s_nop 0
  s_cmp_ge_u32 s15, 156
  s_cbranch_scc1 L_wf_16_o
  s_sleep 1
  s_add_u32 s78, s78, 1
  s_cmp_lt_u32 s78, 1048576
  s_cbranch_scc1 L_wf_16
L_wf_16_o:
  ds_read_b64_tr_b16 v[36:37], v117 offset:0
  ds_read_b64_tr_b16 v[38:39], v117 offset:2048
  ds_read_b64_tr_b16 v[40:41], v117 offset:16384
  ds_read_b64_tr_b16 v[42:43], v117 offset:18432
  ds_read_b64_tr_b16 v[44:45], v118 offset:0
  ds_read_b64_tr_b16 v[46:47], v118 offset:2048
  ds_read_b64_tr_b16 v[48:49], v118 offset:16384
  ds_read_b64_tr_b16 v[50:51], v118 offset:18432
  s_waitcnt vmcnt(0)
L_G3_consume:
  v_mov_b32 v4, v114
  s_nop 1
  v_max_f32_dpp v4, v4, v4 row_ror:8 row_mask:0xf bank_mask:0xf
  s_nop 1
  v_max_f32_dpp v4, v4, v4 row_ror:4 row_mask:0xf bank_mask:0xf
  s_nop 1
  v_max_f32_dpp v4, v4, v4 row_ror:2 row_mask:0xf bank_mask:0xf
  s_nop 1
  v_max_f32_dpp v4, v4, v4 row_ror:1 row_mask:0xf bank_mask:0xf
  v_mov_b32 v5, v4
  s_nop 1
  v_permlane16_swap_b32 v4, v5
  v_max_f32 v4, v4, v5
  s_mov_b32 s68, 0x3fb8aa3b
  v_sub_f32 v5, v114, v4
  v_mul_f32 v5, s68, v5
  v_exp_f32 v7, v5
  s_nop 0
  v_mul_f32 v5, v7, v115
  s_nop 1
  v_add_f32_dpp v5, v5, v5 row_ror:8 row_mask:0xf bank_mask:0xf
  s_nop 1
  v_add_f32_dpp v5, v5, v5 row_ror:4 row_mask:0xf bank_mask:0xf
  s_nop 1
  v_add_f32_dpp v5, v5, v5 row_ror:2 row_mask:0xf bank_mask:0xf
  s_nop 1
  v_add_f32_dpp v5, v5, v5 row_ror:1 row_mask:0xf bank_mask:0xf
  v_mov_b32 v6, v5
  s_nop 1
  v_permlane16_swap_b32 v5, v6
  v_add_f32 v5, v5, v6
  v_rcp_f32 v6, v5
  s_nop 0
  v_fma_f32 v9, -v5, v6, 1.0
  v_fma_f32 v6, v9, v6, v6
  v_mul_f32 v7, v7, v6
  ds_bpermute_b32 v110, v108, v7 offset:0
  ds_bpermute_b32 v111, v108, v7 offset:32
  ds_bpermute_b32 v112, v108, v7 offset:64
  ds_bpermute_b32 v113, v108, v7 offset:96
  s_waitcnt lgkmcnt(0)
  v_mul_f32 v76, v76, v110
  v_mul_f32 v77, v77, v110
  v_mul_f32 v78, v78, v110
  v_mul_f32 v79, v79, v110
  v_fmac_f32 v76, v80, v111
  v_fmac_f32 v77, v81, v111
  v_fmac_f32 v78, v82, v111
  v_fmac_f32 v79, v83, v111
  v_fmac_f32 v76, v84, v112
  v_fmac_f32 v77, v85, v112
  v_fmac_f32 v78, v86, v112
  v_fmac_f32 v79, v87, v112
  v_fmac_f32 v76, v88, v113
  v_fmac_f32 v77, v89, v113
  v_fmac_f32 v78, v90, v113
  v_fmac_f32 v79, v91, v113
  s_nop 0
  v_permlane32_swap_b32 v76, v78
  v_permlane32_swap_b32 v77, v79
  v_add_f32 v76, v76, v78
  v_add_f32 v77, v77, v79
  s_nop 1
  v_permlane16_swap_b32 v76, v77
  v_add_f32 v109, v76, v77
  s_nop 1
  v_add_f32_dpp v109, v109, v109 row_ror:8 row_mask:0xf bank_mask:0xf
  v_cmp_u_f32 vcc, v109, v109
  s_cbranch_vccz L_G3_ok
  s_add_u32 s12, s12, 1
  s_cmp_gt_u32 s12, 16384
  s_cbranch_scc1 L_G3_ok
  s_sleep 3
  global_load_dwordx2 v[114:115], v107, s[46:47] sc1
  global_load_dwordx4 v[76:79], v106, s[46:47] sc1
  global_load_dwordx4 v[80:83], v106, s[62:63] sc1
  global_load_dwordx4 v[84:87], v106, s[64:65] sc1
  global_load_dwordx4 v[88:91], v106, s[66:67] sc1
  s_waitcnt vmcnt(0)
  s_branch L_G3_consume
L_G3_ok:
  s_nop 0
  v_cvt_pk_bf16_f32 v4, v109, v109
  ds_write_b16 v116, v4 offset:6080
  s_branch L_O_j
L_O_nog:
  s_mov_b32 s78, 0
L_wf_17:
  ds_read_b32 v31, v12 offset:8192
  s_waitcnt lgkmcnt(0)
  v_readfirstlane_b32 s15, v31
  s_nop 0
  s_cmp_ge_u32 s15, 156
  s_cbranch_scc1 L_wf_17_o
  s_sleep 1
  s_add_u32 s78, s78, 1
  s_cmp_lt_u32 s78, 1048576
  s_cbranch_scc1 L_wf_17
L_wf_17_o:
  ds_read_b64_tr_b16 v[36:37], v117 offset:0
  ds_read_b64_tr_b16 v[38:39], v117 offset:2048
  ds_read_b64_tr_b16 v[40:41], v117 offset:16384
  ds_read_b64_tr_b16 v[42:43], v117 offset:18432
  ds_read_b64_tr_b16 v[44:45], v118 offset:0
  ds_read_b64_tr_b16 v[46:47], v118 offset:2048
  ds_read_b64_tr_b16 v[48:49], v118 offset:16384
  ds_read_b64_tr_b16 v[50:51], v118 offset:18432
  s_sleep 8
L_O_j:
  s_nop 0
  s_mov_b32 s78, 0
L_O_lr:
  ds_read_b128 v[52:55], v25 offset:6080
  ds_read_b128 v[56:59], v25 offset:6144
  s_waitcnt lgkmcnt(0)
  v_mfma_f32_16x16x32_bf16 v[68:71], v[52:55], v[36:39], 0
  v_mfma_f32_16x16x32_bf16 v[68:71], v[56:59], v[40:43], v[68:71]
  v_mfma_f32_16x16x32_bf16 v[72:75], v[52:55], v[44:47], 0
  v_mfma_f32_16x16x32_bf16 v[72:75], v[56:59], v[48:51], v[72:75]
  s_nop 5
  v_cmp_u_f32 vcc, v68, v69
  s_cbranch_vccz L_O_lo
  s_add_u32 s78, s78, 1
  s_cmp_lt_u32 s78, 131072
  s_cbranch_scc1 L_O_lr
L_O_lo:
  s_nop 0
  s_mov_b64 exec, 0x0000ffff
  global_store_dwordx2 v28, v[68:69], s[48:49] offset:2560 sc1
  global_store_dwordx2 v28, v[72:73], s[48:49] offset:2688 sc1
  s_mov_b64 exec, -1
  s_mov_b32 s78, 0
L_wf_18:
  ds_read_b32 v31, v12 offset:8192
  s_waitcnt lgkmcnt(0)
  v_readfirstlane_b32 s15, v31
  s_nop 0
  s_cmp_ge_u32 s15, 188
  s_cbranch_scc1 L_wf_18_o
  s_sleep 1
  s_add_u32 s78, s78, 1
  s_cmp_lt_u32 s78, 1048576
  s_cbranch_scc1 L_wf_18
L_wf_18_o:
  ds_read_b64_tr_b16 v[36:37], v20 offset:0
  ds_read_b64_tr_b16 v[38:39], v20 offset:1024
  ds_read_b64_tr_b16 v[40:41], v20 offset:8192
  ds_read_b64_tr_b16 v[42:43], v20 offset:9216
  ds_read_b64_tr_b16 v[44:45], v20 offset:16384
  ds_read_b64_tr_b16 v[46:47], v20 offset:17408
  ds_read_b64_tr_b16 v[48:49], v20 offset:24576
  ds_read_b64_tr_b16 v[50:51], v20 offset:25600
  ds_read_b128 v[52:55], v23 offset:0
  ds_read_b128 v[56:59], v23 offset:64
  ds_read_b128 v[60:63], v23 offset:128
  ds_read_b128 v[64:67], v23 offset:192
  s_waitcnt lgkmcnt(0)
  v_mfma_f32_16x16x32_bf16 v[68:71], v[52:55], v[36:39], 0
  v_mfma_f32_16x16x32_bf16 v[68:71], v[56:59], v[40:43], v[68:71]
  v_mfma_f32_16x16x32_bf16 v[68:71], v[60:63], v[44:47], v[68:71]
  v_mfma_f32_16x16x32_bf16 v[68:71], v[64:67], v[48:51], v[68:71]
  s_lshl_b32 s11, s4, 7
  v_add_u32 v4, s11, v27
  s_mov_b64 exec, 0x0000ffff
  s_nop 4
  global_store_dwordx2 v4, v[68:69], s[48:49] offset:1536 sc1
  s_mov_b64 exec, -1
  s_cmp_lt_u32 s2, 224
  s_cbranch_scc0 L_roleR
  v_add_u32 v92, 94208, v22
  v_xor_b32 v93, 32, v92
  s_and_b32 s74, s82, 3
  s_lshr_b32 s75, s82, 2
  s_lshl_b32 s75, s75, 3
  s_add_u32 s75, s75, s81
  v_lshrrev_b32 v4, 4, v0
  v_add_u32 v4, 224, v4
  s_mov_b32 s8, 12416
  v_mul_lo_u32 v94, v4, s8
  v_lshl_add_u32 v94, v2, 3, v94
  v_add_u32 v94, 4608, v94
  s_lshl_b32 s10, s75, 6
  s_lshl_b32 s11, s4, 3
  s_add_u32 s10, s10, s11
  v_and_b32 v4, 7, v1
  v_add_u32 v4, s10, v4
  v_lshlrev_b32 v4, 1, v4
  global_load_ushort v100, v4, s[30:31]
  v_and_b32 v4, 31, v1
  v_add_u32 v4, 224, v4
  v_mul_lo_u32 v108, v4, s8
  v_add_u32 v108, 4736, v108
  v_lshlrev_b32 v4, 3, v3
  s_andn2_b32 s10, s2, 0x18
  v_add_u32 v4, s10, v4
  v_mul_lo_u32 v109, v4, s8
  v_bfe_u32 v5, v1, 3, 1
  v_lshl_add_u32 v109, v5, 9, v109
  v_and_b32 v5, 7, v1
  v_lshl_add_u32 v109, v5, 3, v109
  s_lshl_b32 s11, s4, 6
  s_add_u32 s11, s11, 4608
  v_add_u32 v109, s11, v109
  v_lshrrev_b32 v4, 5, v1
  v_mul_u32_u24 v110, 144, v4
  v_lshl_add_u32 v110, v5, 1, v110
  s_lshl_b32 s11, s4, 4
  v_add_u32 v110, s11, v110
  s_lshr_b32 s10, s4, 2
  s_lshl_b32 s10, s10, 9
  s_and_b32 s11, s4, 3
  s_lshl_b32 s11, s11, 7
  s_add_u32 s10, s10, s11
  s_add_u32 s10, s10, 4608
  v_add_u32 v111, s10, v27
  v_add_u32 v112, 5632, v28
  s_sleep 78
  s_mov_b32 s12, 0
  global_load_dwordx2 v[102:103], v94, s[46:47] sc1
  global_load_dwordx4 v[104:107], v108, s[46:47] sc1
  global_load_dwordx2 v[96:97], v94, s[46:47] offset:256 sc1
  global_load_dwordx2 v[98:99], v94, s[46:47] offset:384 sc1
  s_cmp_eq_u32 s4, 0
  s_cbranch_scc0 L_sp_19
  v_mov_b32 v31, 0
  s_mov_b64 exec, 1
  ds_write_b32 v12, v31 offset:8280
  s_mov_b64 exec, -1
L_sp_19:
  s_mov_b32 s78, 0
L_wf_20:
  ds_read_b32 v31, v12 offset:8192
  s_waitcnt lgkmcnt(0)
  v_readfirstlane_b32 s15, v31
  s_nop 0
  s_cmp_ge_u32 s15, 220
  s_cbranch_scc1 L_wf_20_o
  s_sleep 1
  s_add_u32 s78, s78, 1
  s_cmp_lt_u32 s78, 1048576
  s_cbranch_scc1 L_wf_20
L_wf_20_o:
  ds_read_b64_tr_b16 v[36:37], v19 offset:0
  ds_read_b64_tr_b16 v[38:39], v19 offset:512
  ds_read_b64_tr_b16 v[40:41], v19 offset:4096
  ds_read_b64_tr_b16 v[42:43], v19 offset:4608
  ds_read_b64_tr_b16 v[44:45], v19 offset:8192
  ds_read_b64_tr_b16 v[46:47], v19 offset:8704
  ds_read_b64_tr_b16 v[48:49], v19 offset:12288
  ds_read_b64_tr_b16 v[50:51], v19 offset:12800
  s_waitcnt vmcnt(0)
L_G5_consume:
  v_mov_b32 v113, v104
  v_mov_b32 v114, v105
  v_mov_b32 v115, v106
  v_mov_b32 v116, v107
  v_add_f32_dpp v113, v113, v113 row_ror:8 row_mask:0xf bank_mask:0xf
  v_add_f32_dpp v114, v114, v114 row_ror:8 row_mask:0xf bank_mask:0xf
  v_add_f32_dpp v115, v115, v115 row_ror:8 row_mask:0xf bank_mask:0xf
  v_add_f32_dpp v116, v116, v116 row_ror:8 row_mask:0xf bank_mask:0xf
  v_add_f32_dpp v113, v113, v113 row_ror:4 row_mask:0xf bank_mask:0xf
  v_add_f32_dpp v114, v114, v114 row_ror:4 row_mask:0xf bank_mask:0xf
  v_add_f32_dpp v115, v115, v115 row_ror:4 row_mask:0xf bank_mask:0xf
  v_add_f32_dpp v116, v116, v116 row_ror:4 row_mask:0xf bank_mask:0xf
  v_add_f32_dpp v113, v113, v113 row_ror:2 row_mask:0xf bank_mask:0xf
  v_add_f32_dpp v114, v114, v114 row_ror:2 row_mask:0xf bank_mask:0xf
  v_add_f32_dpp v115, v115, v115 row_ror:2 row_mask:0xf bank_mask:0xf
  v_add_f32_dpp v116, v116, v116 row_ror:2 row_mask:0xf bank_mask:0xf
  v_add_f32_dpp v113, v113, v113 row_ror:1 row_mask:0xf bank_mask:0xf
  v_add_f32_dpp v114, v114, v114 row_ror:1 row_mask:0xf bank_mask:0xf
  v_add_f32_dpp v115, v115, v115 row_ror:1 row_mask:0xf bank_mask:0xf
  v_add_f32_dpp v116, v116, v116 row_ror:1 row_mask:0xf bank_mask:0xf
  v_mov_b32 v4, v113
  v_mov_b32 v5, v114
  v_mov_b32 v6, v115
  v_mov_b32 v7, v116
  v_permlane16_swap_b32 v113, v4
  v_permlane16_swap_b32 v114, v5
  v_permlane16_swap_b32 v115, v6
  v_permlane16_swap_b32 v116, v7
  v_add_f32 v113, v113, v4
  v_add_f32 v114, v114, v5
  v_add_f32 v115, v115, v6
  v_add_f32 v116, v116, v7
  v_cmp_u_f32 vcc, v114, v116
  v_cmp_eq_u32 s[8:9], -1, v102
  s_nop 0
  s_or_b64 vcc, vcc, s[8:9]
  v_cmp_eq_u32 s[8:9], -1, v103
  s_nop 0
  s_or_b64 vcc, vcc, s[8:9]
  v_cmp_eq_u32 s[8:9], -1, v96
  s_nop 0
  s_or_b64 vcc, vcc, s[8:9]
  v_cmp_eq_u32 s[8:9], -1, v97
  s_nop 0
  s_or_b64 vcc, vcc, s[8:9]
  v_cmp_eq_u32 s[8:9], -1, v98
  s_nop 0
  s_or_b64 vcc, vcc, s[8:9]
  v_cmp_eq_u32 s[8:9], -1, v99
  s_nop 0
  s_or_b64 vcc, vcc, s[8:9]
  s_cbranch_vccz L_G5_ok
  s_add_u32 s12, s12, 1
  s_cmp_gt_u32 s12, 16384
  s_cbranch_scc1 L_G5_ok
  s_sleep 3
  global_load_dwordx2 v[102:103], v94, s[46:47] sc1
  global_load_dwordx4 v[104:107], v108, s[46:47] sc1
  global_load_dwordx2 v[96:97], v94, s[46:47] offset:256 sc1
  global_load_dwordx2 v[98:99], v94, s[46:47] offset:384 sc1
  s_waitcnt vmcnt(0)
  s_branch L_G5_consume
L_G5_ok:
  s_nop 0
  v_mul_f32 v113, 0x3a800000, v113
  v_mul_f32 v115, 0x3a800000, v115
  v_mul_f32 v114, 0x3a800000, v114
  v_mul_f32 v116, 0x3a800000, v116
  v_fma_f32 v114, -v113, v113, v114
  v_fma_f32 v116, -v115, v115, v116
  v_cvt_pk_bf16_f32 v4, v113, v115
  v_cvt_pk_bf16_f32 v5, v114, v116
  v_lshlrev_b32 v117, 16, v4
  v_and_b32 v118, 0xffff0000, v4
  v_lshlrev_b32 v6, 16, v5
  v_and_b32 v7, 0xffff0000, v5
  v_add_f32 v6, 0x3727c5ac, v6
  v_add_f32 v7, 0x3727c5ac, v7
  v_cvt_pk_bf16_f32 v5, v6, v7
  v_lshlrev_b32 v6, 16, v5
  v_and_b32 v7, 0xffff0000, v5
  v_sqrt_f32 v6, v6
  v_sqrt_f32 v7, v7
  s_nop 0
  v_cvt_pk_bf16_f32 v5, v6, v7
  v_lshlrev_b32 v119, 16, v5
  v_and_b32 v120, 0xffff0000, v5
  v_rcp_f32 v121, v119
  v_rcp_f32 v122, v120
  v_lshlrev_b32 v123, 16, v102
  v_and_b32 v124, 0xffff0000, v102
  v_lshlrev_b32 v125, 16, v103
  v_and_b32 v126, 0xffff0000, v103
  v_sub_f32 v123, v123, v117
  v_sub_f32 v124, v124, v118
  v_sub_f32 v125, v125, v117
  v_sub_f32 v126, v126, v118
  v_cvt_pk_bf16_f32 v4, v123, v124
  v_cvt_pk_bf16_f32 v5, v125, v126
  v_lshlrev_b32 v123, 16, v4
  v_and_b32 v124, 0xffff0000, v4
  v_lshlrev_b32 v125, 16, v5
  v_and_b32 v126, 0xffff0000, v5
  v_mul_f32 v127, v123, v121
  v_mul_f32 v128, v124, v122
  v_mul_f32 v129, v125, v121
  v_mul_f32 v130, v126, v122
  v_fma_f32 v131, -v127, v119, v123
  v_fma_f32 v132, -v128, v120, v124
  v_fma_f32 v133, -v129, v119, v125
  v_fma_f32 v134, -v130, v120, v126
  v_fma_f32 v127, v131, v121, v127
  v_fma_f32 v128, v132, v122, v128
  v_fma_f32 v129, v133, v121, v129
  v_fma_f32 v130, v134, v122, v130
  v_cvt_pk_bf16_f32 v4, v127, v128
  v_cvt_pk_bf16_f32 v5, v129, v130
  v_lshlrev_b32 v123, 16, v4
  v_and_b32 v124, 0xffff0000, v4
  v_lshlrev_b32 v125, 16, v5
  v_and_b32 v126, 0xffff0000, v5
  v_lshlrev_b32 v127, 16, v96
  v_and_b32 v128, 0xffff0000, v96
  v_lshlrev_b32 v129, 16, v97
  v_and_b32 v130, 0xffff0000, v97
  v_mul_f32 v123, v123, v127
  v_mul_f32 v124, v124, v128
  v_mul_f32 v125, v125, v129
  v_mul_f32 v126, v126, v130
  v_cvt_pk_bf16_f32 v4, v123, v124
  v_cvt_pk_bf16_f32 v5, v125, v126
  v_lshlrev_b32 v123, 16, v4
  v_and_b32 v124, 0xffff0000, v4
  v_lshlrev_b32 v125, 16, v5
  v_and_b32 v126, 0xffff0000, v5
  v_lshlrev_b32 v127, 16, v98
  v_and_b32 v128, 0xffff0000, v98
  v_lshlrev_b32 v129, 16, v99
  v_and_b32 v130, 0xffff0000, v99
  v_add_f32 v123, v123, v127
  v_add_f32 v124, v124, v128
  v_add_f32 v125, v125, v129
  v_add_f32 v126, v126, v130
  v_cvt_pk_bf16_f32 v4, v123, v124
  v_cvt_pk_bf16_f32 v5, v125, v126
  v_lshlrev_b32 v123, 16, v4
  v_and_b32 v124, 0xffff0000, v4
  v_lshlrev_b32 v125, 16, v5
  v_and_b32 v126, 0xffff0000, v5
  v_add_f32 v127, v123, v125
  v_mul_f32 v128, v123, v123
  v_add_f32 v129, v124, v126
  v_mul_f32 v130, v124, v124
  v_fmac_f32 v128, v125, v125
  v_fmac_f32 v130, v126, v126
  v_permlane32_swap_b32 v127, v129
  s_nop 0
  v_permlane32_swap_b32 v128, v130
  v_add_f32 v127, v127, v129
  v_add_f32 v128, v128, v130
  s_nop 1
  v_permlane16_swap_b32 v127, v128
  v_add_f32 v8, v127, v128
  s_nop 1
  v_add_f32_dpp v8, v8, v8 row_ror:8 row_mask:0xf bank_mask:0xf
  s_nop 1
  v_add_f32_dpp v8, v8, v8 row_ror:4 row_mask:0xf bank_mask:0xf
  s_nop 1
  v_add_f32_dpp v8, v8, v8 row_ror:2 row_mask:0xf bank_mask:0xf
  s_nop 1
  v_add_f32_dpp v8, v8, v8 row_ror:1 row_mask:0xf bank_mask:0xf
  v_lshlrev_b32 v9, 5, v3
  s_lshl_b32 s11, s4, 2
  v_add_u32 v9, s11, v9
  s_mov_b32 exec_lo, 0x00010001
  s_mov_b32 exec_hi, 0x00010001
  ds_write_b32 v9, v8 offset:7712
  s_mov_b64 exec, -1
  v_and_b32 v9, 31, v1
  v_lshlrev_b32 v9, 2, v9
  s_mov_b32 s78, 0
L_ST2_lr:
  ds_read_b32 v8, v9 offset:7712
  s_waitcnt lgkmcnt(0)
  v_add_f32_dpp v8, v8, v8 quad_perm:[1,0,3,2] row_mask:0xf bank_mask:0xf
  s_nop 1
  v_add_f32_dpp v8, v8, v8 quad_perm:[2,3,0,1] row_mask:0xf bank_mask:0xf
  s_nop 1
  v_add_f32_dpp v8, v8, v8 row_half_mirror row_mask:0xf bank_mask:0xf
  v_cmp_u_f32 vcc, v8, v8
  s_cbranch_vccz L_ST2_lo
  s_add_u32 s78, s78, 1
  s_cmp_lt_u32 s78, 131072
  s_cbranch_scc1 L_ST2_lr
L_ST2_lo:
  s_nop 0
  v_readlane_b32 s8, v8, 0
  v_readlane_b32 s9, v8, 8
  v_readlane_b32 s10, v8, 16
  v_readlane_b32 s11, v8, 24
  v_mov_b32 v113, s8
  v_mov_b32 v114, s9
  v_mov_b32 v115, s10
  v_mov_b32 v116, s11
  v_mul_f32 v113, 0x3a800000, v113
  v_mul_f32 v115, 0x3a800000, v115
  v_mul_f32 v114, 0x3a800000, v114
  v_mul_f32 v116, 0x3a800000, v116
  v_fma_f32 v114, -v113, v113, v114
  v_fma_f32 v116, -v115, v115, v116
  v_cvt_pk_bf16_f32 v4, v113, v115
  v_cvt_pk_bf16_f32 v5, v114, v116
  v_lshlrev_b32 v117, 16, v4
  v_and_b32 v118, 0xffff0000, v4
  v_lshlrev_b32 v6, 16, v5
  v_and_b32 v7, 0xffff0000, v5
  v_add_f32 v6, 0x3727c5ac, v6
  v_add_f32 v7, 0x3727c5ac, v7
  v_cvt_pk_bf16_f32 v5, v6, v7
  v_lshlrev_b32 v6, 16, v5
  v_and_b32 v7, 0xffff0000, v5
  v_sqrt_f32 v6, v6
  v_sqrt_f32 v7, v7
  s_nop 0
  v_cvt_pk_bf16_f32 v5, v6, v7
  v_lshlrev_b32 v119, 16, v5
  v_and_b32 v120, 0xffff0000, v5
  v_rcp_f32 v121, v119
  v_rcp_f32 v122, v120
  v_sub_f32 v123, v123, v117
  v_sub_f32 v124, v124, v118
  v_sub_f32 v125, v125, v117
  v_sub_f32 v126, v126, v118
  v_cvt_pk_bf16_f32 v4, v123, v124
  v_cvt_pk_bf16_f32 v5, v125, v126
  v_lshlrev_b32 v123, 16, v4
  v_and_b32 v124, 0xffff0000, v4
  v_lshlrev_b32 v125, 16, v5
  v_and_b32 v126, 0xffff0000, v5
  v_mul_f32 v127, v123, v121
  v_mul_f32 v128, v124, v122
  v_mul_f32 v129, v125, v121
  v_mul_f32 v130, v126, v122
  v_fma_f32 v131, -v127, v119, v123
  v_fma_f32 v132, -v128, v120, v124
  v_fma_f32 v133, -v129, v119, v125
  v_fma_f32 v134, -v130, v120, v126
  v_fma_f32 v127, v131, v121, v127
  v_fma_f32 v128, v132, v122, v128
  v_fma_f32 v129, v133, v121, v129
  v_fma_f32 v130, v134, v122, v130
  v_cvt_pk_bf16_f32 v4, v127, v128
  v_cvt_pk_bf16_f32 v5, v129, v130
  s_lshr_b32 s10, s4, 1
  s_cmp_eq_u32 s10, s74
  s_cbranch_scc0 L_F1_noxf
  s_mov_b32 s11, 0x05040100
  v_perm_b32 v6, v5, v4, s11
  s_mov_b32 s11, 0x07060302
  v_perm_b32 v7, v5, v4, s11
  v_and_b32 v8, 127, v0
  v_lshlrev_b32 v8, 2, v8
  ds_write_b32 v8, v6 offset:6368
  ds_write_b32 v8, v7 offset:6896
L_F1_noxf:
  s_nop 0
  s_mov_b32 s78, 0
L_F1_lr:
  ds_read_b128 v[52:55], v26 offset:6368
  ds_read_b128 v[56:59], v26 offset:6432
  ds_read_b128 v[60:63], v26 offset:6496
  ds_read_b128 v[64:67], v26 offset:6560
  s_waitcnt lgkmcnt(0)
  v_mfma_f32_16x16x32_bf16 v[68:71], v[52:55], v[36:39], 0
  v_mfma_f32_16x16x32_bf16 v[68:71], v[56:59], v[40:43], v[68:71]
  v_mfma_f32_16x16x32_bf16 v[68:71], v[60:63], v[44:47], v[68:71]
  v_mfma_f32_16x16x32_bf16 v[68:71], v[64:67], v[48:51], v[68:71]
  s_nop 7
  v_cmp_u_f32 vcc, v68, v69
  s_cbranch_vccz L_F1_lo
  s_add_u32 s78, s78, 1
  s_cmp_lt_u32 s78, 131072
  s_cbranch_scc1 L_F1_lr
L_F1_lo:
  s_nop 0
  s_mov_b64 exec, 0x0000ffff
  global_store_dwordx2 v111, v[68:69], s[48:49] sc1
  s_mov_b64 exec, -1
  s_sleep 7
  s_mov_b32 s12, 0
  global_load_dwordx2 v[76:77], v109, s[46:47] sc1
  s_cmp_eq_u32 s4, 0
  s_cbranch_scc0 L_sp_21
  v_mov_b32 v31, 0
  s_mov_b64 exec, 1
  ds_write_b32 v12, v31 offset:8280
  s_mov_b64 exec, -1
L_sp_21:
  s_mov_b32 s78, 0
L_wf_22:
  ds_read_b32 v31, v12 offset:8192
  s_waitcnt lgkmcnt(0)
  v_readfirstlane_b32 s15, v31
  s_nop 0
  s_cmp_ge_u32 s15, 252
  s_cbranch_scc1 L_wf_22_o
  s_sleep 1
  s_add_u32 s78, s78, 1
  s_cmp_lt_u32 s78, 1048576
  s_cbranch_scc1 L_wf_22
L_wf_22_o:
  ds_read_b64_tr_b16 v[36:37], v92 offset:0
  ds_read_b64_tr_b16 v[38:39], v92 offset:2048
  ds_read_b64_tr_b16 v[40:41], v92 offset:16384
  ds_read_b64_tr_b16 v[42:43], v92 offset:18432
  ds_read_b64_tr_b16 v[44:45], v93 offset:0
  ds_read_b64_tr_b16 v[46:47], v93 offset:2048
  ds_read_b64_tr_b16 v[48:49], v93 offset:16384
  ds_read_b64_tr_b16 v[50:51], v93 offset:18432
  s_waitcnt vmcnt(0)
L_G6_consume:
  v_permlane32_swap_b32 v76, v77
  v_add_f32 v76, v76, v77
  v_mov_b32 v4, v76
  s_nop 1
  v_permlane16_swap_b32 v76, v4
  v_add_f32 v76, v76, v4
  s_nop 1
  v_add_f32_dpp v76, v76, v76 row_ror:8 row_mask:0xf bank_mask:0xf
  v_cmp_u_f32 vcc, v76, v76
  s_cbranch_vccz L_G6_ok
  s_add_u32 s12, s12, 1
  s_cmp_gt_u32 s12, 16384
  s_cbranch_scc1 L_G6_ok
  s_sleep 3
  global_load_dwordx2 v[76:77], v109, s[46:47] sc1
  s_waitcnt vmcnt(0)
  s_branch L_G6_consume
L_G6_ok:
  s_nop 0
  v_cvt_pk_bf16_f32 v4, v76, v76
  v_lshlrev_b32 v4, 16, v4
  v_lshlrev_b32 v100, 16, v100
  v_add_f32 v4, v4, v100
  v_cvt_pk_bf16_f32 v4, v4, v4
  v_lshlrev_b32 v4, 16, v4
  v_mul_f32 v5, v4, v4
  s_mov_b32 s68, 0x3d372713
  v_fma_f32 v5, v5, s68, 1.0
  v_mul_f32 v5, v5, v4
  v_mul_f32 v5, 0x40135761, v5
  v_min_f32 v5, 0x42800000, v5
  v_exp_f32 v5, v5
  s_nop 0
  v_add_f32 v6, 1.0, v5
  v_rcp_f32 v6, v6
  v_mul_f32 v5, v5, v4
  v_mul_f32 v5, v5, v6
  v_cvt_pk_bf16_f32 v5, v5, v5
  ds_write_b16 v110, v5 offset:7424
  s_mov_b32 s78, 0
L_F2_lr:
  ds_read_b128 v[52:55], v25 offset:7424
  ds_read_b128 v[56:59], v25 offset:7488
  s_waitcnt lgkmcnt(0)
  v_mfma_f32_16x16x32_bf16 v[68:71], v[52:55], v[36:39], 0
  v_mfma_f32_16x16x32_bf16 v[68:71], v[56:59], v[40:43], v[68:71]
  v_mfma_f32_16x16x32_bf16 v[72:75], v[52:55], v[44:47], 0
  v_mfma_f32_16x16x32_bf16 v[72:75], v[56:59], v[48:51], v[72:75]
  s_nop 5
  v_cmp_u_f32 vcc, v68, v69
  s_cbranch_vccz L_F2_lo
  s_add_u32 s78, s78, 1
  s_cmp_lt_u32 s78, 131072
  s_cbranch_scc1 L_F2_lr
L_F2_lo:
  s_nop 0
  s_mov_b64 exec, 0x0000ffff
  global_store_dwordx2 v112, v[68:69], s[48:49] offset:0 sc1
  global_store_dwordx2 v112, v[72:73], s[48:49] offset:128 sc1
  s_mov_b64 exec, -1
  s_branch L_end
L_roleR:
  s_sleep 16
  s_mov_b32 s12, 0
  global_load_dwordx4 v[76:79], v149, s[46:47] sc1
  global_load_dwordx4 v[80:83], v149, s[26:27] sc1
  global_load_dwordx4 v[84:87], v141, s[46:47] sc1
  s_cmp_eq_u32 s4, 0
  s_cbranch_scc0 L_sp_23
  v_mov_b32 v31, 0
  s_mov_b64 exec, 1
  ds_write_b32 v12, v31 offset:8280
  s_mov_b64 exec, -1
L_sp_23:
  s_mov_b32 s78, 0
L_wf_24:
  ds_read_b32 v31, v12 offset:8272
  s_waitcnt lgkmcnt(0)
  v_readfirstlane_b32 s15, v31
  s_nop 0
  s_cmp_ge_u32 s15, 8
  s_cbranch_scc1 L_wf_24_o
  s_add_u32 s78, s78, 1
  s_cmp_lt_u32 s78, 1048576
  s_cbranch_scc1 L_wf_24
L_wf_24_o:
  s_waitcnt vmcnt(0)
L_G4_consume:
  v_add_f32 v76, v76, v80
  v_add_f32 v77, v77, v81
  v_add_f32 v78, v78, v82
  v_add_f32 v79, v79, v83
  s_nop 0
  v_permlane32_swap_b32 v76, v78
  v_permlane32_swap_b32 v77, v79
  v_add_f32 v76, v76, v78
  v_add_f32 v77, v77, v79
  s_nop 1
  v_permlane16_swap_b32 v76, v77
  v_add_f32 v143, v76, v77
  v_permlane32_swap_b32 v84, v86
  v_permlane32_swap_b32 v85, v87
  v_add_f32 v84, v84, v86
  v_add_f32 v85, v85, v87
  s_nop 1
  v_permlane16_swap_b32 v84, v85
  v_add_f32 v153, v84, v85
  v_cmp_u_f32 vcc, v143, v153
  s_cbranch_vccz L_G4_ok
  s_add_u32 s12, s12, 1
  s_cmp_gt_u32 s12, 16384
  s_cbranch_scc1 L_G4_ok
  s_sleep 3
  global_load_dwordx4 v[76:79], v149, s[46:47] sc1
  global_load_dwordx4 v[80:83], v149, s[26:27] sc1
  global_load_dwordx4 v[84:87], v141, s[46:47] sc1
  s_waitcnt vmcnt(0)
  s_branch L_G4_consume
L_G4_ok:
  s_nop 0
  ds_write_b32 v142, v143 offset:14336
  ds_write_b32 v142, v153 offset:12288
  s_cmp_eq_u32 s4, 1
  s_cbranch_scc0 L_R_w1
  s_mov_b32 s78, 0
L_MR_lr:
  ds_read_b32 v52, v146 offset:12800
  ds_read_b32 v53, v146 offset:13056
  ds_read_b32 v54, v146 offset:13312
  ds_read_b32 v55, v146 offset:13568
  s_waitcnt lgkmcnt(0)
  v_add_f32 v5, v52, v53
  v_add_f32 v6, v54, v55
  v_cmp_u_f32 vcc, v5, v6
  s_cbranch_vccz L_MR_lo
  s_add_u32 s78, s78, 1
  s_cmp_lt_u32 s78, 131072
  s_cbranch_scc1 L_MR_lr
L_MR_lo:
  s_nop 0
  v_cvt_pk_bf16_f32 v6, v6, v6
  v_lshlrev_b32 v6, 16, v6
  v_add_f32 v6, 1.0, v6
  v_mov_b32 v9, v6
  v_mov_b32 v8, v6
  s_nop 1
  v_permlane32_swap_b32 v8, v9
  v_cvt_pk_bf16_f32 v8, v8, v9
  v_mov_b32 v9, v5
  v_mov_b32 v10, v5
  s_nop 1
  v_permlane32_swap_b32 v10, v9
  v_cvt_pk_bf16_f32 v10, v10, v9
  s_mov_b32 exec_lo, 0xffffffff
  s_mov_b32 exec_hi, 0x00000000
  global_store_dword v148, v8, s[48:49] offset:256 sc1
  global_store_dword v148, v10, s[48:49] offset:384 sc1
  s_mov_b64 exec, -1
L_R_w1:
  s_nop 1
  s_cmp_eq_u32 s4, 0
  s_cbranch_scc0 L_R_w2
  s_mov_b32 s78, 0
L_R_lr:
  ds_read_b32 v52, v146 offset:14336
  ds_read_b32 v53, v146 offset:14592
  ds_read_b32 v54, v146 offset:14848
  ds_read_b32 v55, v146 offset:15104
  ds_read_b32 v56, v146 offset:15360
  ds_read_b32 v57, v146 offset:15616
  ds_read_b32 v58, v146 offset:15872
  ds_read_b32 v59, v146 offset:16128
  ds_read_b32 v44, v146 offset:12288
  ds_read_b32 v45, v146 offset:12544
  ds_read_b32 v50, v146 offset:13824
  ds_read_b32 v51, v146 offset:14080
  s_waitcnt lgkmcnt(0)
  v_add_f32 v52, v52, v53
  v_add_f32 v54, v54, v55
  v_add_f32 v56, v56, v57
  v_add_f32 v58, v58, v59
  v_add_f32 v151, v44, v45
  v_add_f32 v152, v50, v51
  v_add_f32 v52, v52, v54
  v_add_f32 v56, v56, v58
  v_add_f32 v5, v151, v152
  v_add_f32 v4, v52, v56
  v_cmp_u_f32 vcc, v4, v5
  s_cbranch_vccz L_R_lo
  s_add_u32 s78, s78, 1
  s_cmp_lt_u32 s78, 131072
  s_cbranch_scc1 L_R_lr
L_R_lo:
  s_nop 0
  v_cvt_pk_bf16_f32 v5, v4, v151
  v_lshlrev_b32 v4, 16, v5
  v_and_b32 v151, 0xffff0000, v5
  v_mul_f32 v4, v151, v4
  v_cvt_pk_bf16_f32 v4, v4, v4
  v_lshlrev_b32 v4, 16, v4
  v_lshlrev_b32 v144, 16, v144
  v_add_f32 v4, v144, v4
  v_cvt_pk_bf16_f32 v154, v4, v4
  v_lshlrev_b32 v154, 16, v154
  v_mov_b32 v9, v154
  v_mov_b32 v8, v154
  s_nop 1
  v_permlane32_swap_b32 v8, v9
  v_cvt_pk_bf16_f32 v8, v8, v9
  s_mov_b32 exec_lo, 0xffffffff
  s_mov_b32 exec_hi, 0x00000000
  global_store_dword v148, v8, s[48:49] sc1
  s_mov_b64 exec, -1
  v_mov_b32 v4, v154
  v_mul_f32 v5, v154, v154
  s_nop 0
  v_add_f32_dpp v4, v4, v4 row_ror:8 row_mask:0xf bank_mask:0xf
  v_add_f32_dpp v5, v5, v5 row_ror:8 row_mask:0xf bank_mask:0xf
  s_nop 0
  v_add_f32_dpp v4, v4, v4 row_ror:4 row_mask:0xf bank_mask:0xf
  v_add_f32_dpp v5, v5, v5 row_ror:4 row_mask:0xf bank_mask:0xf
  s_nop 0
  v_add_f32_dpp v4, v4, v4 row_ror:2 row_mask:0xf bank_mask:0xf
  v_add_f32_dpp v5, v5, v5 row_ror:2 row_mask:0xf bank_mask:0xf
  s_nop 0
  v_add_f32_dpp v4, v4, v4 row_ror:1 row_mask:0xf bank_mask:0xf
  v_add_f32_dpp v5, v5, v5 row_ror:1 row_mask:0xf bank_mask:0xf
  v_mov_b32 v6, v4
  s_nop 1
  v_permlane16_swap_b32 v4, v6
  v_add_f32 v4, v4, v6
  v_mov_b32 v7, v5
  s_nop 1
  v_permlane16_swap_b32 v5, v7
  v_add_f32 v5, v5, v7
  v_readlane_b32 s8, v4, 0
  v_readlane_b32 s9, v5, 0
  v_readlane_b32 s10, v4, 32
  v_readlane_b32 s11, v5, 32
  v_mov_b32 v40, s8
  v_mov_b32 v41, s9
  v_mov_b32 v42, s10
  v_mov_b32 v43, s11
  s_mov_b64 exec, 1
  global_store_dwordx4 v148, v[40:43], s[48:49] offset:128 sc1
  s_mov_b64 exec, -1
  v_cvt_pk_bf16_f32 v152, v152, v152
  v_lshlrev_b32 v152, 16, v152
  v_lshlrev_b32 v145, 16, v145
L_R_w2:
  s_nop 1
  s_cmp_eq_u32 s4, 7
  s_cbranch_scc1 L_Rf_zero
  s_sleep 88
  s_mov_b32 s12, 0
  global_load_dwordx4 v[76:79], v150, s[46:47] sc1
  global_load_dwordx4 v[80:83], v150, s[52:53] sc1
  s_cmp_eq_u32 s4, 0
  s_cbranch_scc0 L_sp_25
  v_mov_b32 v31, 0
  s_mov_b64 exec, 1
  ds_write_b32 v12, v31 offset:8280
  s_mov_b64 exec, -1
L_sp_25:
  s_waitcnt vmcnt(0)
L_G7_consume:
  v_add_f32 v76, v76, v80
  v_add_f32 v77, v77, v81
  v_add_f32 v78, v78, v82
  v_add_f32 v79, v79, v83
  s_nop 0
  v_permlane32_swap_b32 v76, v78
  v_permlane32_swap_b32 v77, v79
  v_add_f32 v76, v76, v78
  v_add_f32 v77, v77, v79
  s_nop 1
  v_permlane16_swap_b32 v76, v77
  v_add_f32 v143, v76, v77
  v_cmp_u_f32 vcc, v143, v143
  s_cbranch_vccz L_G7_ok
  s_add_u32 s12, s12, 1
  s_cmp_gt_u32 s12, 16384
  s_cbranch_scc1 L_G7_ok
  s_sleep 3
  global_load_dwordx4 v[76:79], v150, s[46:47] sc1
  global_load_dwordx4 v[80:83], v150, s[52:53] sc1
  s_waitcnt vmcnt(0)
  s_branch L_G7_consume
L_G7_ok:
  s_nop 0
  s_branch L_Rf_j
L_Rf_zero:
  v_mov_b32 v143, 0
L_Rf_j:
  s_nop 0
  ds_write_b32 v142, v143 offset:16384
  s_cmp_eq_u32 s4, 0
  s_cbranch_scc0 L_end
  s_mov_b32 s78, 0
L_Rf_lr:
  ds_read_b32 v52, v146 offset:16384
  ds_read_b32 v53, v146 offset:16640
  ds_read_b32 v54, v146 offset:16896
  ds_read_b32 v55, v146 offset:17152
  ds_read_b32 v56, v146 offset:17408
  ds_read_b32 v57, v146 offset:17664
  ds_read_b32 v58, v146 offset:17920
  ds_read_b32 v59, v146 offset:18176
  s_waitcnt lgkmcnt(0)
  v_add_f32 v52, v52, v53
  v_add_f32 v54, v54, v55
  v_add_f32 v56, v56, v57
  v_add_f32 v58, v58, v59
  v_add_f32 v52, v52, v54
  v_add_f32 v56, v56, v58
  v_add_f32 v4, v52, v56
  v_cmp_u_f32 vcc, v4, v4
  s_cbranch_vccz L_Rf_lo
  s_add_u32 s78, s78, 1
  s_cmp_lt_u32 s78, 131072
  s_cbranch_scc1 L_Rf_lr
L_Rf_lo:
  s_nop 0
  v_cvt_pk_bf16_f32 v4, v4, v4
  v_lshlrev_b32 v4, 16, v4
  v_add_f32 v4, v4, v145
  v_cvt_pk_bf16_f32 v4, v4, v4
  v_lshlrev_b32 v4, 16, v4
  v_mul_f32 v4, v152, v4
  v_cvt_pk_bf16_f32 v4, v4, v4
  v_lshlrev_b32 v4, 16, v4
  v_add_f32 v4, v154, v4
  v_cvt_pk_bf16_f32 v4, v4, v4
  global_store_short v147, v4, s[40:41]
  s_cmp_eq_u32 s73, 0
  s_cbranch_scc0 L_end
  v_mov_b32 v5, 0
  v_mov_b32 v6, s5
  s_mov_b64 exec, 1
  global_store_dword v5, v6, s[44:45] sc1
  s_mov_b64 exec, -1
  s_branch L_end
L_end:
L_exit:
L_codeend:
  s_endpgm
.section .rodata,"a"
.p2align 6
.amdhsa_kernel adaLN_cond__sliding_block_cached__mixer_channel_mlp__decode_kernel
  .amdhsa_next_free_vgpr 160
  .amdhsa_next_free_sgpr 102
  .amdhsa_accum_offset 160
  .amdhsa_group_segment_fixed_size 0
  .amdhsa_kernarg_size 120
  .amdhsa_user_sgpr_count 2
  .amdhsa_user_sgpr_kernarg_segment_ptr 1
  .amdhsa_system_sgpr_workgroup_id_x 1
  .amdhsa_float_denorm_mode_32 3
.end_amdhsa_kernel
```
